```python
import torch

def _softmax(x, axis=-1):
    return torch.softmax(x, dim=axis)

def _gelu(x):
    return torch.nn.functional.gelu(x, approximate='tanh')

def _silu(x):
    return torch.nn.functional.silu(x)

def _sigmoid(x):
    return torch.sigmoid(x)

def _layernorm(x, axis=-1, eps=1e-05):
    m = x.mean(dim=axis, keepdim=True)
    v = x.var(dim=axis, keepdim=True, unbiased=False)
    return (x - m) / torch.sqrt(v + eps)

def _scatter_add(tgt, idx, src, axis=0):
    return tgt.clone().index_add_(axis, idx, src)

def _segment_sum(src, seg, n):
    out = torch.zeros((n,) + src.shape[1:], dtype=src.dtype)
    return out.index_add_(0, seg, src)

def _pad(x, pw):
    flat = tuple((v for pair in reversed(pw) for v in pair))
    return torch.nn.functional.pad(x, flat)
kernel_name = 'adaLN_cond__sliding_local_dilated__glu_gated_glu__prompt'

def setup_inputs():

    _w = lambda a: (lambda t: t.to(torch.bfloat16) if t.is_floating_point() else t)(torch.as_tensor(a))

    def _A_setup():
        B, S, D = (1, 2048, 512)
        return {'x': _w((lambda *s: torch.randn(*s, dtype=torch.bfloat16) * 0.05)(B, S, D)), 'wqkv': _w((lambda *s: torch.randn(*s, dtype=torch.bfloat16) * 0.05)(D, 3 * D)), 'wo': _w((lambda *s: torch.randn(*s, dtype=torch.bfloat16) * 0.05)(D, D))}
    _A_in = _A_setup()

    def _B_setup():
        B, S, D, F = (1, 2048, 512, 1376)
        return {'x': _w((lambda *s: torch.randn(*s, dtype=torch.bfloat16) * 0.05)(B, S, D)), 'w_gate': _w((lambda *s: torch.randn(*s, dtype=torch.bfloat16) * 0.05)(D, F)), 'w_up': _w((lambda *s: torch.randn(*s, dtype=torch.bfloat16) * 0.05)(D, F)), 'w_down': _w((lambda *s: torch.randn(*s, dtype=torch.bfloat16) * 0.05)(F, D))}
    _B_in = _B_setup()
    return {'A_x': _A_in['x'], 'A_wqkv': _A_in['wqkv'], 'A_wo': _A_in['wo'], 'B_x': _B_in['x'], 'B_w_gate': _B_in['w_gate'], 'B_w_up': _B_in['w_up'], 'B_w_down': _B_in['w_down'], 'c': _w((lambda *s: torch.randn(*s, dtype=torch.bfloat16) * 0.1)(1, 512) * 8.0), 'w_mod': _w((lambda *s: torch.randn(*s, dtype=torch.bfloat16) * 0.1)(512, 6 * 512) * 512 ** (-0.5) * 8.0)}

def reference(A_x, A_wqkv, A_wo, B_x, B_w_gate, B_w_up, B_w_down, c, w_mod):

    def _A_ref(x, wqkv, wo):
        B, S, D = x.shape
        H = 32
        Dh = D // H
        W, dil = (8, 2)
        qkv = (lambda x, *d: x.permute(*d))((x @ wqkv).reshape(B, S, 3, H, Dh), 2, 0, 3, 1, 4)
        q, k, v = (qkv[0], qkv[1], qkv[2])
        scale = Dh ** (-0.5)
        pos = torch.arange(S)
        off = torch.arange(W) * dil
        idx = pos[:, None] - off[None, :]
        mask = idx >= 0
        idx_c = torch.where(mask, idx, 0).reshape(-1)
        kg = k[:, :, idx_c, :].reshape(B, H, S, W, Dh)
        vg = v[:, :, idx_c, :].reshape(B, H, S, W, Dh)
        logits = torch.einsum('bhsd,bhswd->bhsw', q, kg) * scale
        logits = torch.where(mask[None, None, :, :], logits, -1000000000.0)
        attn = _softmax(logits, axis=-1)
        o = torch.einsum('bhsw,bhswd->bhsd', attn, vg)
        return (lambda x, *d: x.permute(*d))(o, 0, 2, 1, 3).reshape(B, S, D) @ wo

    def _B_ref(x, w_gate, w_up, w_down):
        g = torch.einsum('bsd,df->bsf', x, w_gate)
        u = torch.einsum('bsd,df->bsf', x, w_up)
        h = _sigmoid(g) * u
        return torch.einsum('bsf,fd->bsd', h, w_down)
    x = A_x
    mod = (_silu(c) @ w_mod).reshape(c.shape[0], 6, 1, -1)
    sa, ca, ga, sb, cb, gb = (mod[:, 0].clone(), mod[:, 1].clone(), mod[:, 2].clone(), mod[:, 3].clone(), mod[:, 4].clone(), mod[:, 5].clone())
    h = _layernorm(x, axis=-1) * (1 + ca) + sa
    x = x + ga * _A_ref(h, A_wqkv, A_wo)
    h = _layernorm(x, axis=-1) * (1 + cb) + sb
    x = x + gb * _B_ref(h, B_w_gate, B_w_up, B_w_down)
    return x
```

```asm
; @launch grid=(256,1,1) block=(256,1,1) lds=163840
.amdgcn_target "amdgcn-amd-amdhsa--gfx950"
.text
.globl adaLN_cond__sliding_local_dilated__glu_gated_glu__prompt_kernel
.p2align 8
.type adaLN_cond__sliding_local_dilated__glu_gated_glu__prompt_kernel,@function
adaLN_cond__sliding_local_dilated__glu_gated_glu__prompt_kernel:
    s_cmp_ge_u32 s2, 256
    s_cbranch_scc1 L_giveup
    s_load_dwordx2 s[40:41], s[0:1], 0
    s_load_dwordx2 s[64:65], s[0:1], 64
    s_load_dwordx2 s[76:77], s[0:1], 56
    s_load_dwordx2 s[44:45], s[0:1], 8
    s_load_dwordx2 s[72:73], s[0:1], 88
    v_lshrrev_b32 v2, 6, v0
    v_and_b32 v0, 63, v0
    v_readfirstlane_b32 s4, v2
    s_lshr_b32 s7, s2, 3
    s_and_b32 s3, s2, 7
    s_lshr_b32 s10, s7, 3
    s_lshl_b32 s5, s3, 2
    s_add_u32 s5, s5, s10
    s_and_b32 s6, s7, 7
    s_lshl_b32 s12, s6, 2
    s_add_u32 s12, s12, s4
    s_mul_i32 s12, s12, 20
    s_lshl_b32 s13, s5, 9
    s_add_u32 s12, s12, s13
    s_addk_i32 s12, -128
    v_add_lshl_u32 v7, s12, v0, 7
    v_cmp_gt_u32 vcc, 20, v0
    v_bfrev_b32 v6, -2
    s_mov_b32 s34, 0x20000
    s_mov_b32 s42, 2097152
    v_cndmask_b32 v14, v6, v7, vcc
    s_mov_b32 s43, s34
    s_getpc_b64 s[14:15]
    v_lshlrev_b32_e64 v1, 4, v0
    s_lshl_b32 s12, s7, 2
    s_add_u32 s12, s12, s4
    s_and_b32 s12, s12, 63
    s_min_u32 s12, s12, (L_codeend-adaLN_cond__sliding_local_dilated__glu_gated_glu__prompt_kernel)/1024-1
    s_lshl_b32 s12, s12, 10
    s_and_b32 s14, s14, 0xffffff00
    v_add_u32 v4, s12, v1
    global_load_dwordx4 a[244:247], v4, s[14:15]
    s_waitcnt lgkmcnt(0)
    buffer_load_dword v10, v14, s[40:43], 0 offen
    s_load_dword s8, s[72:73], 978944
    s_load_dwordx2 s[48:49], s[0:1], 16
    s_load_dwordx2 s[52:53], s[0:1], 32
    s_load_dwordx2 s[56:57], s[0:1], 40
    s_load_dwordx2 s[60:61], s[0:1], 48
    s_load_dwordx2 s[68:69], s[0:1], 72
    s_mov_b32 s66, 3145728
    s_mov_b32 s67, s34
    s_mov_b32 s78, 1024
    s_mov_b32 s79, s34
    s_mov_b32 s46, 1572864
    s_mov_b32 s47, s34
    s_and_b32 s10, s7, 3
    s_lshr_b32 s12, s7, 2
    s_lshl_b32 s13, s12, 1
    s_add_u32 s13, s13, s10
    s_add_u32 s13, s13, 7
    s_cmp_eq_u32 s10, 0
    s_cselect_b32 s12, s12, s13
    s_lshl_b32 s12, s12, 3
    s_add_u32 s3, s3, s12
    s_lshl_b32 s12, s4, 3
    v_lshrrev_b32 v76, 3, v0
    v_add_u32 v76, s12, v76
    v_and_b32 v77, 7, v0
    v_lshlrev_b32 v75, 3, v76
    v_mul_u32_u24 v74, 24576, v76
    v_lshl_add_u32 v74, v77, 4, v74
    s_and_b32 s13, s3, 3
    s_lshr_b32 s14, s3, 2
    s_mul_i32 s29, s13, 786432
    s_lshl_b32 s30, s14, 7
    s_add_u32 s29, s29, s30
    s_lshl_b32 s33, s13, 8
    s_add_u32 s30, s29, 6144
    s_add_u32 s31, s29, 12288
    s_add_u32 s32, s29, 18432
    s_cmp_eq_u32 s10, 0
    s_cbranch_scc0 L_ml_1
    buffer_load_dwordx2 v[32:33], v75, s[76:79], s33 offen
    buffer_load_dwordx4 v[16:19], v74, s[64:67], s29 offen
    buffer_load_dwordx4 v[20:23], v74, s[64:67], s30 offen
    buffer_load_dwordx4 v[24:27], v74, s[64:67], s31 offen
    buffer_load_dwordx4 v[28:31], v74, s[64:67], s32 offen
L_ml_1:
    s_lshl_b32 s15, s2, 2
    s_add_u32 s15, s15, s4
    s_mul_i32 s12, s15, 12
    v_add_lshl_u32 v7, s12, v0, 7
    v_cmp_gt_u32 vcc, 12, v0
    v_lshrrev_b32 v12, 2, v0
    v_and_b32_e64 v13, 3, v0
    v_cndmask_b32 v54, v6, v7, vcc
    s_lshl_b32 s12, s7, 2
    s_add_u32 s12, s12, s4
    s_lshl_b32 s12, s12, 2
    v_add_lshl_u32 v7, s12, v0, 10
    v_cmp_gt_u32 vcc, 4, v0
    s_nop 1
    v_cndmask_b32 v55, v6, v7, vcc
    v_lshlrev_b32 v4, 11, v12
    v_lshl_add_u32 v4, v13, 4, v4
    s_lshl_b32 s16, s5, 16
    s_lshl_b32 s17, s4, 8
    s_add_u32 s16, s16, s17
    s_add_u32 s18, s16, 32768
    v_bfe_u32 v5, v0, 4, 1
    s_and_b32 s12, s4, 1
    s_lshl_b32 s12, s12, 1
    v_add_u32 v5, s12, v5
    v_lshlrev_b32 v5, 1, v5
    v_xor_b32 v5, v77, v5
    v_lshlrev_b32_e64 v5, 4, v5
    v_mul_u32_u24 v8, 3072, v76
    v_add_u32_e64 v8, v8, v5
    v_lshl_add_u32 v56, v76, 10, v5
    s_mul_i32 s20, s4, 3072
    s_lshl_b32 s21, s6, 7
    buffer_load_dwordx4 v[84:87], v4, s[40:43], s16 offen offset:0
    buffer_load_dwordx4 v[124:127], v4, s[40:43], s16 offen offset:64
    s_mov_b32 s74, 16777216
    s_mov_b32 s75, s34
    s_mov_b32 s50, 524288
    s_mov_b32 s51, s34
    s_mov_b32 s54, 1409024
    s_mov_b32 s55, s34
    s_mov_b32 s58, 1409024
    s_mov_b32 s59, s34
    s_mov_b32 s62, 1409024
    s_mov_b32 s63, s34
    s_mov_b32 s70, 2097152
    s_mov_b32 s71, s34
    s_mul_i32 s12, s15, 6
    v_add_lshl_u32 v7, s12, v0, 7
    v_cmp_gt_u32 vcc, 6, v0
    v_lshrrev_b32 v2, 4, v0
    v_and_b32 v3, 15, v0
    v_cndmask_b32 v11, v6, v7, vcc
    v_lshlrev_b32 v5, 1, v12
    v_cmp_lt_u32 vcc, 7, v12
    v_mov_b32_e64 v6, -16
    v_mov_b32 v7, -31
    s_lshl_b32 s15, s5, 6
    v_cndmask_b32 v6, v6, v7, vcc
    v_add3_u32 v5, v5, v6, s15
    v_max_i32 v5, 0, v5
    v_lshlrev_b32 v5, 10, v5
    v_lshl_add_u32 v5, v13, 4, v5
    v_lshlrev_b32 v6, 1, v2
    v_xor_b32 v6, v77, v6
    v_lshlrev_b32_e64 v6, 4, v6
    v_lshl_add_u32 v62, v76, 10, v6
    s_lshl_b32 s23, s4, 10
    s_getreg_b32 s11, hwreg(HW_REG_XCC_ID)
    s_and_b32 s11, s11, 15
    s_mov_b32 s85, 0x3f803f80
    s_mov_b32 s86, 0xffff0000
    s_mov_b32 s87, 0x40000
    s_lshr_b32 s84, s5, 1
    s_lshl_b32 s82, s84, 20
    s_add_u32 s84, s82, 983040
    v_bfe_u32 v78, v0, 2, 2
    v_mul_u32_u24 v9, 3072, v2
    v_lshl_add_u32 v9, v78, 7, v9
    v_and_b32 v78, 2, v78
    v_and_b32_e64 v6, 1, v2
    v_lshl_add_u32 v78, v6, 2, v78
    v_lshrrev_b32 v6, 1, v13
    s_lshl_b32 s12, s4, 1
    v_add_u32 v6, s12, v6
    v_xor_b32 v6, v6, v78
    v_lshl_add_u32 v9, v6, 4, v9
    v_and_b32_e64 v79, 1, v13
    v_lshl_add_u32 v9, v79, 3, v9
    v_add_u32 v9, 12288, v9
    s_mov_b32 s24, 917504
    s_mov_b32 s25, 929792
    s_mov_b32 s26, 942080
    s_mov_b32 s27, 954368
    s_mov_b32 s12, 357913942
    v_add_u32_e64 v6, 0, v0
    v_mul_hi_u32 v7, v6, s12
    v_mul_u32_u24 v78, 12, v7
    v_sub_u32 v6, v6, v78
    v_lshrrev_b32 v78, 1, v7
    v_and_b32 v78, 2, v78
    v_xor_b32_e64 v6, v6, v78
    v_mul_u32_u24 v7, 2752, v7
    v_lshl_add_u32 v57, v6, 4, v7
    v_lshlrev_b32 v44, 27, v6
    v_add_u32 v6, 64, v0
    v_mul_hi_u32 v7, v6, s12
    v_mul_u32_u24 v78, 12, v7
    v_sub_u32 v6, v6, v78
    v_lshrrev_b32 v78, 1, v7
    v_and_b32 v78, 2, v78
    v_xor_b32_e64 v6, v6, v78
    v_mul_u32_u24 v7, 2752, v7
    v_lshl_add_u32 v58, v6, 4, v7
    v_lshlrev_b32_e64 v45, 27, v6
    v_add_u32 v6, 128, v0
    v_mul_hi_u32 v7, v6, s12
    v_mul_u32_u24 v78, 12, v7
    v_sub_u32 v6, v6, v78
    v_lshrrev_b32 v78, 1, v7
    v_and_b32 v78, 2, v78
    v_xor_b32_e64 v6, v6, v78
    v_mul_u32_u24 v7, 2752, v7
    v_lshl_add_u32 v59, v6, 4, v7
    v_lshlrev_b32_e64 v46, 27, v6
    s_and_b32 s12, s5, 1
    s_lshl_b32 s12, s12, 3
    s_add_u32 s12, s12, s6
    s_lshl_b32 s80, s12, 2
    s_mul_i32 s12, s12, 43
    s_add_u32 s13, s12, 43
    s_lshr_b32 s12, s12, 4
    s_lshr_b32 s13, s13, 4
    s_sub_u32 s89, s13, s12
    s_lshl_b32 s90, s12, 1
    s_sub_u32 s13, 3, s89
    s_mul_i32 s13, s13, 1073741824
    v_and_or_b32 v57, v44, s13, v57
    v_and_or_b32 v58, v45, s13, v58
    v_and_or_b32 v59, v46, s13, v59
    s_lshr_b32 s13, s4, 1
    s_mul_i32 s14, s13, 44032
    s_lshl_b32 s91, s12, 6
    s_add_u32 s91, s91, s14
    s_mul_i32 s13, s13, 3072
    s_and_b32 s14, s4, 1
    s_mul_i32 s14, s14, 6176
    s_add_u32 s13, s13, s14
    s_add_u32 s81, s13, 12288
    s_lshl_b32 s13, s4, 12
    s_add_u32 s39, s13, 94208
    v_and_b32 v78, 1, v2
    v_lshrrev_b32 v79, 1, v2
    v_lshlrev_b32_e64 v6, 14, v78
    v_lshl_add_u32 v6, v79, 8, v6
    v_lshl_add_u32 v60, v3, 4, v6
    v_lshlrev_b32_e64 v6, 11, v3
    v_lshl_add_u32 v6, v78, 5, v6
    v_lshl_add_u32 v61, v79, 4, v6
    s_lshr_b32 s12, s4, 1
    s_lshl_b32 s12, s12, 15
    s_and_b32 s13, s4, 1
    s_lshl_b32 s13, s13, 10
    s_add_u32 s12, s12, s13
    s_lshl_b32 s13, s5, 16
    s_add_u32 s12, s12, s13
    s_add_u32 s88, s12, s21
    s_and_b32 s15, s5, 1
    s_lshl_b32 s14, s15, 16
    s_add_u32 s14, s14, s82
    s_lshl_b32 s12, s6, 11
    s_lshl_b32 s13, s4, 9
    s_add_u32 s12, s12, s13
    s_add_u32 s12, s12, s14
    s_add_u32 s96, s12, 196608
    s_lshl_b32 s12, s4, 14
    s_add_u32 s12, s12, s14
    s_add_u32 s35, s12, 196608
    s_lshl_b32 s13, s6, 11
    s_add_u32 s12, s12, s13
    s_add_u32 s97, s12, 327680
    s_lshr_b32 s13, s4, 1
    s_lshl_b32 s13, s13, 10
    s_add_u32 s12, s82, s13
    s_and_b32 s13, s4, 1
    s_lshl_b32 s13, s13, 16
    s_add_u32 s12, s12, s13
    s_add_u32 s36, s12, 327680
    s_lshl_b32 s12, s15, 13
    s_lshl_b32 s13, s4, 11
    s_add_u32 s12, s12, s13
    s_add_u32 s12, s12, s82
    s_add_u32 s37, s12, 458752
    s_lshl_b32 s13, s6, 8
    s_add_u32 s99, s37, s13
    s_and_b32 s12, s4, 1
    s_xor_b32 s13, s12, 1
    s_mul_i32 s12, s12, 180224
    s_mul_i32 s13, s13, 180224
    s_add_u32 s14, s90, s4
    s_lshl_b32 s14, s14, 10
    s_add_u32 s14, s14, s82
    s_add_u32 s14, s14, 524288
    s_add_u32 s98, s12, s14
    s_add_u32 s83, s13, s14
    s_mul_i32 s12, s15, 180224
    s_add_u32 s12, s12, s82
    s_add_u32 s12, s12, 524288
    s_lshr_b32 s13, s4, 1
    s_mul_i32 s13, s13, 88064
    s_add_u32 s12, s12, s13
    s_and_b32 s13, s4, 1
    s_lshl_b32 s13, s13, 8
    s_add_u32 s38, s12, s13
    s_add_u32 s12, s23, 4096
    v_lshl_add_u32 v63, v2, 4, s12
    v_lshlrev_b32 v77, 2, v0
    v_and_b32 v78, 31, v0
    v_lshlrev_b32 v78, 4, v78
    v_lshrrev_b32 v79, 5, v0
    v_lshl_add_u32 v78, v79, 11, v78
    s_lshl_b32 s12, s4, 9
    v_add_u32 v78, s12, v78
    v_cvt_f32_u32_e64 v79, v79
    s_add_u32 s12, s23, 4096
    v_add_u32 v76, s12, v1
    v_lshlrev_b32 v6, 1, v13
    v_xor_b32_e64 v6, v6, v12
    v_lshl_add_u32 v6, v13, 4, v6
    v_lshlrev_b32_e64 v6, 4, v6
    s_mul_i32 s13, s4, 5120
    s_add_u32 s13, s13, 12288
    v_lshlrev_b32 v12, 5, v13
    v_add_u32 v12, s12, v12
    v_add_u32 v13, s13, v6
    v_lshlrev_b32 v6, 1, v2
    v_xor_b32_e64 v6, v6, v3
    v_lshl_add_u32 v6, v2, 4, v6
    v_lshlrev_b32_e64 v6, 4, v6
    v_add_u32 v14, 12288, v6
    buffer_load_dword v10, v54, s[44:47], 0 offen
    s_sub_u32 s22, 0x180, s44
    s_and_b32 s22, s22, 0x380
    s_add_u32 s22, s22, 0
    buffer_load_dword v10, v55, s[44:47], s22 offen
    s_sub_u32 s22, 0x180, s44
    s_and_b32 s22, s22, 0x380
    s_add_u32 s22, s22, 524288
    buffer_load_dword v10, v55, s[44:47], s22 offen
    s_sub_u32 s22, 0x180, s44
    s_and_b32 s22, s22, 0x380
    s_add_u32 s22, s22, 1048576
    buffer_load_dword v10, v55, s[44:47], s22 offen
    s_sub_u32 s13, s5, 1
    s_lshr_b32 s13, s13, 31
    s_lshl_b32 s13, s13, 6
    s_mov_b32 s12, 0xf149f2ca
    v_lshlrev_b32 v40, 2, v2
    v_mov_b32 v42, s12
    v_add_u32 v41, 0, v40
    v_sub_u32 v43, v3, v41
    v_cmp_gt_u32_e64 vcc, 8, v43
    v_cmp_ge_i32 s[14:15], -9, v43
    v_add_u32_e64 v43, s13, v43
    v_cndmask_b32 v240, v42, 0, vcc
    v_cndmask_b32 v244, v42, 0, s[14:15]
    v_cmp_ge_i32_e64 vcc, -9, v43
    v_cmp_gt_i32 s[14:15], 0, v43
    v_cmp_lt_u32 s[18:19], 7, v41
    v_cndmask_b32 v252, v42, 0, vcc
    v_cndmask_b32 v248, v42, 0, s[14:15]
    v_cndmask_b32 v248, v248, v42, s[18:19]
    v_add_u32 v41, 1, v40
    v_sub_u32 v43, v3, v41
    v_cmp_gt_u32_e64 vcc, 8, v43
    v_cmp_ge_i32 s[14:15], -9, v43
    v_add_u32_e64 v43, s13, v43
    v_cndmask_b32 v241, v42, 0, vcc
    v_cndmask_b32 v245, v42, 0, s[14:15]
    v_cmp_ge_i32_e64 vcc, -9, v43
    v_cmp_gt_i32 s[14:15], 0, v43
    v_cmp_lt_u32 s[18:19], 7, v41
    v_cndmask_b32 v253, v42, 0, vcc
    v_cndmask_b32 v249, v42, 0, s[14:15]
    v_cndmask_b32 v249, v249, v42, s[18:19]
    v_add_u32 v41, 2, v40
    v_sub_u32 v43, v3, v41
    v_cmp_gt_u32_e64 vcc, 8, v43
    v_cmp_ge_i32 s[14:15], -9, v43
    v_add_u32_e64 v43, s13, v43
    v_cndmask_b32 v242, v42, 0, vcc
    v_cndmask_b32 v246, v42, 0, s[14:15]
    v_cmp_ge_i32_e64 vcc, -9, v43
    v_cmp_gt_i32 s[14:15], 0, v43
    v_cmp_lt_u32 s[18:19], 7, v41
    v_cndmask_b32 v254, v42, 0, vcc
    v_cndmask_b32 v250, v42, 0, s[14:15]
    v_cndmask_b32 v250, v250, v42, s[18:19]
    v_add_u32 v41, 3, v40
    v_sub_u32 v43, v3, v41
    v_cmp_gt_u32_e64 vcc, 8, v43
    v_cmp_ge_i32 s[14:15], -9, v43
    v_add_u32_e64 v43, s13, v43
    v_cndmask_b32 v243, v42, 0, vcc
    v_cndmask_b32 v247, v42, 0, s[14:15]
    v_cmp_ge_i32_e64 vcc, -9, v43
    v_cmp_gt_i32 s[14:15], 0, v43
    v_cmp_lt_u32 s[18:19], 7, v41
    v_cndmask_b32 v255, v42, 0, vcc
    v_cndmask_b32 v251, v42, 0, s[14:15]
    v_cndmask_b32 v251, v251, v42, s[18:19]
    v_lshlrev_b32_e64 v64, 4, v3
    v_lshl_add_u32 v64, v2, 11, v64
    s_lshl_b32 s12, s6, 8
    s_add_u32 s12, s12, 4096
    v_add_u32 v64, s12, v64
    v_mov_b32_e64 v65, v55
    s_add_u32 s12, s23, 4096
    v_add_u32 v66, s12, v1
    v_cmp_eq_u32 vcc, 2, v2
    v_mov_b32 v67, 0
    s_nop 0
    v_cndmask_b32 v67, v67, 1.0, vcc
    v_bfe_u32 v40, v0, 2, 2
    v_and_b32_e64 v41, 3, v0
    v_lshl_add_u32 v42, v2, 3, v40
    v_and_b32 v43, 2, v40
    v_and_b32 v44, 1, v2
    v_lshl_add_u32 v43, v44, 2, v43
    v_lshlrev_b32 v42, 7, v42
    v_and_b32 v40, 1, v41
    v_lshl_add_u32 v42, v40, 3, v42
    v_add_u32 v42, 94208, v42
    v_lshrrev_b32 v41, 1, v41
    v_add_u32 v40, 0, v41
    v_xor_b32_e64 v40, v40, v43
    v_lshl_add_u32 v68, v40, 4, v42
    v_add_u32 v40, 2, v41
    v_xor_b32 v40, v40, v43
    v_lshl_add_u32 v69, v40, 4, v42
    v_add_u32 v40, 4, v41
    v_xor_b32 v40, v40, v43
    v_lshl_add_u32 v70, v40, 4, v42
    v_add_u32 v40, 6, v41
    v_xor_b32 v40, v40, v43
    v_lshl_add_u32 v71, v40, 4, v42
    v_add_u32 v40, 159744, v1
    ds_write_b128 v40, v[240:243] offset:0
    ds_write_b128 v40, v[244:247] offset:1024
    ds_write_b128 v40, v[248:251] offset:2048
    ds_write_b128 v40, v[252:255] offset:3072
    ds_write_b128 v1, v[68:71] offset:10240
    v_accvgpr_write_b32 a250, v64
    v_accvgpr_write_b32 a251, v65
    v_accvgpr_write_b32 a252, v66
    v_accvgpr_write_b32 a253, v67
    s_add_u32 s18, s16, 32768
    s_waitcnt lgkmcnt(0)
    s_bitcmp1_b32 s4, 0
    s_cselect_b32 s92, s56, s52
    s_cselect_b32 s93, s57, s53
    s_mov_b32 s94, 1409024
    s_mov_b32 s95, s34
    s_mul_i32 s8, s8, 1664525
    s_add_u32 s8, s8, 1013904223
    s_cmp_lg_u32 s4, 1
    s_cbranch_scc1 L_x_2
    s_and_b32 s12, s8, 0xfffffff0
    s_or_b32 s12, s12, s11
    s_add_u32 s13, s80, s84
    s_mov_b64 exec, 1
    v_mov_b32 v6, s12
    buffer_store_dword v6, off, s[72:75], s13 sc1
    s_mov_b64 exec, -1
L_x_2:
    s_cmp_eq_u32 s10, 0
    s_cbranch_scc1 L_nomod_3
    buffer_load_dwordx4 v[164:167], v4, s[40:43], s16 offen offset:128
    buffer_load_dwordx4 v[204:207], v4, s[40:43], s16 offen offset:192
    buffer_load_dwordx4 v[92:95], v4, s[40:43], s16 offen offset:1024
    buffer_load_dwordx4 v[132:135], v4, s[40:43], s16 offen offset:1088
    buffer_load_dwordx4 v[172:175], v4, s[40:43], s16 offen offset:1152
    buffer_load_dwordx4 v[212:215], v4, s[40:43], s16 offen offset:1216
    buffer_load_dwordx4 v[100:103], v4, s[40:43], s18 offen offset:0
    buffer_load_dwordx4 v[140:143], v4, s[40:43], s18 offen offset:64
    buffer_load_dwordx4 v[180:183], v4, s[40:43], s18 offen offset:128
    buffer_load_dwordx4 v[220:223], v4, s[40:43], s18 offen offset:192
    s_branch L_mj_5
L_nomod_3:
    s_waitcnt vmcnt(6)
    v_lshlrev_b32 v44, 16, v32
    buffer_load_dwordx4 v[164:167], v4, s[40:43], s16 offen offset:128
    v_and_b32 v45, s86, v32
    v_lshlrev_b32 v46, 16, v33
    v_and_b32_e64 v47, s86, v33
    v_mul_f32 v48, 0xbfb8aa3b, v44
    v_mul_f32 v49, 0xbfb8aa3b, v45
    v_mul_f32 v50, 0xbfb8aa3b, v46
    v_mul_f32 v51, 0xbfb8aa3b, v47
    v_exp_f32_e64 v48, v48
    buffer_load_dwordx4 v[204:207], v4, s[40:43], s16 offen offset:192
    v_exp_f32 v49, v49
    v_exp_f32 v50, v50
    v_exp_f32 v51, v51
    v_add_f32 v48, 1.0, v48
    v_add_f32 v49, 1.0, v49
    v_add_f32 v50, 1.0, v50
    v_add_f32 v51, 1.0, v51
    v_rcp_f32 v48, v48
    v_rcp_f32_e64 v49, v49
    buffer_load_dwordx4 v[92:95], v4, s[40:43], s16 offen offset:1024
    v_rcp_f32 v50, v50
    v_rcp_f32 v51, v51
    v_mul_f32 v44, v44, v48
    v_mul_f32 v45, v45, v49
    v_mul_f32 v46, v46, v50
    v_mul_f32 v47, v47, v51
    v_cvt_pk_bf16_f32 v36, v44, 0
    v_cvt_pk_bf16_f32 v40, 0, v44
    v_cvt_pk_bf16_f32 v37, v45, 0
    buffer_load_dwordx4 v[132:135], v4, s[40:43], s16 offen offset:1088
    v_cvt_pk_bf16_f32 v41, 0, v45
    v_cvt_pk_bf16_f32 v38, v46, 0
    v_cvt_pk_bf16_f32 v42, 0, v46
    v_cvt_pk_bf16_f32 v39, v47, 0
    v_cvt_pk_bf16_f32 v43, 0, v47
    v_dot2_f32_bf16 v44, v16, v36, 0
    v_dot2_f32_bf16 v45, v16, v40, 0
    v_dot2_f32_bf16 v46, v17, v36, 0
    v_dot2_f32_bf16 v47, v17, v40, 0
    buffer_load_dwordx4 v[172:175], v4, s[40:43], s16 offen offset:1152
    v_dot2_f32_bf16 v48, v18, v36, 0
    v_dot2_f32_bf16 v49, v18, v40, 0
    v_dot2_f32_bf16 v50, v19, v36, 0
    v_dot2_f32_bf16 v51, v19, v40, 0
    v_dot2_f32_bf16 v44, v20, v37, v44
    v_dot2_f32_bf16 v45, v20, v41, v45
    v_dot2_f32_bf16 v46, v21, v37, v46
    v_dot2_f32_bf16 v47, v21, v41, v47
    v_dot2_f32_bf16 v48, v22, v37, v48
    buffer_load_dwordx4 v[212:215], v4, s[40:43], s16 offen offset:1216
    v_dot2_f32_bf16 v49, v22, v41, v49
    v_dot2_f32_bf16 v50, v23, v37, v50
    v_dot2_f32_bf16 v51, v23, v41, v51
    v_dot2_f32_bf16 v44, v24, v38, v44
    v_dot2_f32_bf16 v45, v24, v42, v45
    v_dot2_f32_bf16 v46, v25, v38, v46
    v_dot2_f32_bf16 v47, v25, v42, v47
    v_dot2_f32_bf16 v48, v26, v38, v48
    buffer_load_dwordx4 v[100:103], v4, s[40:43], s18 offen offset:0
    v_dot2_f32_bf16 v49, v26, v42, v49
    v_dot2_f32_bf16 v50, v27, v38, v50
    v_dot2_f32_bf16 v51, v27, v42, v51
    v_dot2_f32_bf16 v44, v28, v39, v44
    v_dot2_f32_bf16 v45, v28, v43, v45
    v_dot2_f32_bf16 v46, v29, v39, v46
    v_dot2_f32_bf16 v47, v29, v43, v47
    v_dot2_f32_bf16 v48, v30, v39, v48
    v_dot2_f32_bf16 v49, v30, v43, v49
    buffer_load_dwordx4 v[140:143], v4, s[40:43], s18 offen offset:64
    v_dot2_f32_bf16 v50, v31, v39, v50
    v_dot2_f32_bf16 v51, v31, v43, v51
    v_and_b32 v6, 7, v0
    v_lshlrev_b32 v6, 5, v6
    v_and_b32_e64 v7, 1, v2
    v_lshl_add_u32 v6, v7, 3, v6
    v_permlane32_swap_b32 v44, v45
    v_permlane32_swap_b32 v46, v47
    v_permlane32_swap_b32 v48, v49
    buffer_load_dwordx4 v[180:183], v4, s[40:43], s18 offen offset:128
    v_permlane32_swap_b32 v50, v51
    v_add_f32 v44, v44, v45
    v_add_f32 v46, v46, v47
    v_add_f32 v48, v48, v49
    v_add_f32 v50, v50, v51
    v_lshrrev_b32_e64 v7, 1, v2
    v_lshl_add_u32 v6, v7, 2, v6
    v_permlane16_swap_b32 v44, v46
    v_permlane16_swap_b32 v48, v50
    buffer_load_dwordx4 v[220:223], v4, s[40:43], s18 offen offset:192
    v_add_f32 v44, v44, v46
    v_add_f32 v48, v48, v50
    s_lshl_b32 s28, s4, 8
    v_add_u32 v6, s28, v6
    v_add_f32_dpp v45, v44, v44 row_ror:8 row_mask:0xf bank_mask:0xf
    v_add_f32_dpp v49, v48, v48 row_ror:8 row_mask:0xf bank_mask:0xf
    ds_write_b32 v6, v45 offset:2560
    ds_write_b32 v6, v49 offset:2576
    s_waitcnt lgkmcnt(0)
    s_barrier
    v_mov_b32 v52, v4
    v_mov_b32 v53, v5
    s_cmp_lg_u32 s4, 0
    s_cbranch_scc1 L_nomod_4
    v_lshlrev_b32_e64 v4, 4, v3
    ds_read_b128 v[16:19], v4 offset:2560
    ds_read_b128 v[20:23], v4 offset:2816
    ds_read_b128 v[24:27], v4 offset:3072
    ds_read_b128 v[28:31], v4 offset:3328
    s_and_b32 s13, s8, 0xff
    s_mov_b32 s14, 0xffffff00
    v_mov_b32 v5, s13
    s_and_b32 s12, s3, 3
    s_mul_i32 s12, s12, 12288
    s_lshr_b32 s13, s3, 2
    s_lshl_b32 s13, s13, 8
    s_add_u32 s12, s12, s13
    s_add_u32 s12, s12, 917504
    s_waitcnt lgkmcnt(0)
    v_pk_add_f32 v[16:17], v[16:17], v[20:21]
    v_pk_add_f32 v[24:25], v[24:25], v[28:29]
    v_pk_add_f32 v[18:19], v[18:19], v[22:23]
    v_pk_add_f32 v[26:27], v[26:27], v[30:31]
    v_pk_add_f32 v[16:17], v[16:17], v[24:25]
    v_pk_add_f32 v[18:19], v[18:19], v[26:27]
    v_and_or_b32 v16, v16, s14, v5
    v_and_or_b32 v17, v17, s14, v5
    v_and_or_b32 v18, v18, s14, v5
    v_and_or_b32 v19, v19, s14, v5
    s_mov_b64 exec, 0xffff
    buffer_store_dwordx4 v[16:19], v4, s[72:75], s12 offen sc1
    s_mov_b64 exec, -1
    s_nop 0
L_nomod_4:
    v_mov_b32 v4, v52
    v_mov_b32 v5, v53
L_mj_5:
    s_sub_u32 s12, s10, 1
    s_cmp_lt_u32 s12, 2
    s_cselect_b32 s12, 0, 0x40000000
    v_or_b32 v74, s12, v74
    v_or_b32_e64 v75, s12, v75
    v_accvgpr_write_b32 a254, v74
    v_accvgpr_write_b32 a255, v75
    s_waitcnt vmcnt(8)
    v_dot2_f32_bf16 v16, v84, s85, 0
    v_dot2_f32_bf16 v17, v84, v84, 0
    v_dot2_f32_bf16 v16, v85, s85, v16
    v_dot2_f32_bf16 v17, v85, v85, v17
    buffer_load_dwordx4 v[108:111], v4, s[40:43], s18 offen offset:1024
    v_dot2_f32_bf16 v16, v86, s85, v16
    v_dot2_f32_bf16 v17, v86, v86, v17
    v_dot2_f32_bf16 v16, v87, s85, v16
    v_dot2_f32_bf16 v17, v87, v87, v17
    v_dot2_f32_bf16 v16, v124, s85, v16
    v_dot2_f32_bf16 v17, v124, v124, v17
    v_dot2_f32_bf16 v16, v125, s85, v16
    v_dot2_f32_bf16 v17, v125, v125, v17
    v_dot2_f32_bf16 v16, v126, s85, v16
    v_dot2_f32_bf16 v17, v126, v126, v17
    v_dot2_f32_bf16 v16, v127, s85, v16
    v_dot2_f32_bf16 v17, v127, v127, v17
    v_dot2_f32_bf16 v16, v164, s85, v16
    v_dot2_f32_bf16 v17, v164, v164, v17
    v_dot2_f32_bf16 v16, v165, s85, v16
    v_dot2_f32_bf16 v17, v165, v165, v17
    buffer_load_dwordx4 v[148:151], v4, s[40:43], s18 offen offset:1088
    v_dot2_f32_bf16 v16, v166, s85, v16
    v_dot2_f32_bf16 v17, v166, v166, v17
    v_dot2_f32_bf16 v16, v167, s85, v16
    v_dot2_f32_bf16 v17, v167, v167, v17
    v_dot2_f32_bf16 v16, v204, s85, v16
    v_dot2_f32_bf16 v17, v204, v204, v17
    v_dot2_f32_bf16 v16, v205, s85, v16
    v_dot2_f32_bf16 v17, v205, v205, v17
    v_dot2_f32_bf16 v16, v206, s85, v16
    v_dot2_f32_bf16 v17, v206, v206, v17
    v_dot2_f32_bf16 v16, v207, s85, v16
    v_dot2_f32_bf16 v17, v207, v207, v17
    v_lshlrev_b32 v80, 16, v84
    v_and_b32 v81, s86, v84
    v_lshlrev_b32 v82, 16, v85
    v_and_b32_e64 v83, s86, v85
    buffer_load_dwordx4 v[188:191], v4, s[40:43], s18 offen offset:1152
    v_lshlrev_b32 v84, 16, v86
    v_and_b32 v85, s86, v86
    v_lshlrev_b32 v86, 16, v87
    v_and_b32 v87, s86, v87
    v_lshlrev_b32 v120, 16, v124
    v_and_b32 v121, s86, v124
    v_lshlrev_b32 v122, 16, v125
    v_and_b32 v123, s86, v125
    v_lshlrev_b32 v124, 16, v126
    v_and_b32 v125, s86, v126
    v_lshlrev_b32 v126, 16, v127
    v_and_b32 v127, s86, v127
    v_lshlrev_b32 v160, 16, v164
    v_and_b32 v161, s86, v164
    v_lshlrev_b32 v162, 16, v165
    v_and_b32 v163, s86, v165
    buffer_load_dwordx4 v[228:231], v4, s[40:43], s18 offen offset:1216
    v_lshlrev_b32 v164, 16, v166
    v_and_b32 v165, s86, v166
    v_lshlrev_b32 v166, 16, v167
    v_and_b32 v167, s86, v167
    v_lshlrev_b32 v200, 16, v204
    v_and_b32 v201, s86, v204
    v_lshlrev_b32 v202, 16, v205
    v_and_b32 v203, s86, v205
    v_lshlrev_b32 v204, 16, v206
    v_and_b32 v205, s86, v206
    v_lshlrev_b32 v206, 16, v207
    v_and_b32_e64 v207, s86, v207
    s_waitcnt vmcnt(8)
    v_dot2_f32_bf16 v18, v92, s85, 0
    v_dot2_f32_bf16 v19, v92, v92, 0
    v_dot2_f32_bf16 v18, v93, s85, v18
    buffer_load_dwordx4 v[116:119], v5, s[40:43], s17 offen offset:0
    v_dot2_f32_bf16 v19, v93, v93, v19
    v_dot2_f32_bf16 v18, v94, s85, v18
    v_dot2_f32_bf16 v19, v94, v94, v19
    v_dot2_f32_bf16 v18, v95, s85, v18
    v_dot2_f32_bf16 v19, v95, v95, v19
    v_dot2_f32_bf16 v18, v132, s85, v18
    v_dot2_f32_bf16 v19, v132, v132, v19
    v_dot2_f32_bf16 v18, v133, s85, v18
    v_dot2_f32_bf16 v19, v133, v133, v19
    v_dot2_f32_bf16 v18, v134, s85, v18
    v_dot2_f32_bf16 v19, v134, v134, v19
    v_dot2_f32_bf16 v18, v135, s85, v18
    v_dot2_f32_bf16 v19, v135, v135, v19
    v_dot2_f32_bf16 v18, v172, s85, v18
    v_dot2_f32_bf16 v19, v172, v172, v19
    v_dot2_f32_bf16 v18, v173, s85, v18
    buffer_load_dwordx4 v[156:159], v5, s[40:43], s17 offen offset:64
    v_dot2_f32_bf16 v19, v173, v173, v19
    v_dot2_f32_bf16 v18, v174, s85, v18
    v_dot2_f32_bf16 v19, v174, v174, v19
    v_dot2_f32_bf16 v18, v175, s85, v18
    v_dot2_f32_bf16 v19, v175, v175, v19
    v_dot2_f32_bf16 v18, v212, s85, v18
    v_dot2_f32_bf16 v19, v212, v212, v19
    v_dot2_f32_bf16 v18, v213, s85, v18
    v_dot2_f32_bf16 v19, v213, v213, v19
    v_dot2_f32_bf16 v18, v214, s85, v18
    v_dot2_f32_bf16 v19, v214, v214, v19
    v_dot2_f32_bf16 v18, v215, s85, v18
    v_dot2_f32_bf16 v19, v215, v215, v19
    v_lshlrev_b32 v88, 16, v92
    v_and_b32 v89, s86, v92
    v_lshlrev_b32_e64 v90, 16, v93
    buffer_load_dwordx4 v[196:199], v5, s[40:43], s17 offen offset:128
    v_and_b32 v91, s86, v93
    v_lshlrev_b32 v92, 16, v94
    v_and_b32 v93, s86, v94
    v_lshlrev_b32 v94, 16, v95
    v_and_b32 v95, s86, v95
    v_lshlrev_b32 v128, 16, v132
    v_and_b32 v129, s86, v132
    v_lshlrev_b32 v130, 16, v133
    v_and_b32 v131, s86, v133
    v_lshlrev_b32 v132, 16, v134
    v_and_b32 v133, s86, v134
    v_lshlrev_b32 v134, 16, v135
    v_and_b32 v135, s86, v135
    v_lshlrev_b32 v168, 16, v172
    v_and_b32 v169, s86, v172
    v_lshlrev_b32 v170, 16, v173
    buffer_load_dwordx4 v[236:239], v5, s[40:43], s17 offen offset:192
    v_and_b32 v171, s86, v173
    v_lshlrev_b32 v172, 16, v174
    v_and_b32 v173, s86, v174
    v_lshlrev_b32 v174, 16, v175
    v_and_b32 v175, s86, v175
    v_lshlrev_b32 v208, 16, v212
    v_and_b32 v209, s86, v212
    v_lshlrev_b32 v210, 16, v213
    v_and_b32 v211, s86, v213
    v_lshlrev_b32 v212, 16, v214
    v_and_b32 v213, s86, v214
    v_lshlrev_b32 v214, 16, v215
    v_and_b32 v215, s86, v215
    s_waitcnt vmcnt(8)
    v_dot2_f32_bf16 v20, v100, s85, 0
    v_dot2_f32_bf16 v21, v100, v100, 0
    s_add_u32 m0, s20, 12288
    s_add_u32 s22, s21, 0
    buffer_load_dwordx4 v8, s[44:47], s22 offen offset:0 lds
    v_dot2_f32_bf16 v20, v101, s85, v20
    v_dot2_f32_bf16 v21, v101, v101, v21
    v_dot2_f32_bf16 v20, v102, s85, v20
    v_dot2_f32_bf16 v21, v102, v102, v21
    v_dot2_f32_bf16 v20, v103, s85, v20
    v_dot2_f32_bf16 v21, v103, v103, v21
    v_dot2_f32_bf16 v20, v140, s85, v20
    v_dot2_f32_bf16 v21, v140, v140, v21
    v_dot2_f32_bf16 v20, v141, s85, v20
    v_dot2_f32_bf16 v21, v141, v141, v21
    v_dot2_f32_bf16 v20, v142, s85, v20
    v_dot2_f32_bf16 v21, v142, v142, v21
    v_dot2_f32_bf16 v20, v143, s85, v20
    v_dot2_f32_bf16 v21, v143, v143, v21
    v_dot2_f32_bf16 v20, v180, s85, v20
    v_dot2_f32_bf16 v21, v180, v180, v21
    buffer_load_dwordx4 v8, s[44:47], s22 offen offset:1024 lds
    v_dot2_f32_bf16 v20, v181, s85, v20
    v_dot2_f32_bf16 v21, v181, v181, v21
    v_dot2_f32_bf16 v20, v182, s85, v20
    v_dot2_f32_bf16 v21, v182, v182, v21
    v_dot2_f32_bf16 v20, v183, s85, v20
    v_dot2_f32_bf16 v21, v183, v183, v21
    v_dot2_f32_bf16 v20, v220, s85, v20
    v_dot2_f32_bf16 v21, v220, v220, v21
    v_dot2_f32_bf16 v20, v221, s85, v20
    v_dot2_f32_bf16 v21, v221, v221, v21
    v_dot2_f32_bf16 v20, v222, s85, v20
    v_dot2_f32_bf16 v21, v222, v222, v21
    v_dot2_f32_bf16 v20, v223, s85, v20
    v_dot2_f32_bf16 v21, v223, v223, v21
    v_lshlrev_b32 v96, 16, v100
    v_and_b32_e64 v97, s86, v100
    buffer_load_dwordx4 v8, s[44:47], s22 offen offset:2048 lds
    v_lshlrev_b32 v98, 16, v101
    v_and_b32 v99, s86, v101
    v_lshlrev_b32 v100, 16, v102
    v_and_b32 v101, s86, v102
    v_lshlrev_b32 v102, 16, v103
    v_and_b32 v103, s86, v103
    v_lshlrev_b32 v136, 16, v140
    v_and_b32 v137, s86, v140
    v_lshlrev_b32 v138, 16, v141
    v_and_b32 v139, s86, v141
    v_lshlrev_b32 v140, 16, v142
    v_and_b32 v141, s86, v142
    v_lshlrev_b32 v142, 16, v143
    v_and_b32 v143, s86, v143
    v_lshlrev_b32 v176, 16, v180
    v_and_b32 v177, s86, v180
    s_add_u32 m0, s20, 24576
    s_add_u32 s22, s21, 393216
    buffer_load_dwordx4 v8, s[44:47], s22 offen offset:0 lds
    v_lshlrev_b32 v178, 16, v181
    v_and_b32 v179, s86, v181
    v_lshlrev_b32 v180, 16, v182
    v_and_b32 v181, s86, v182
    v_lshlrev_b32 v182, 16, v183
    v_and_b32 v183, s86, v183
    v_lshlrev_b32 v216, 16, v220
    v_and_b32 v217, s86, v220
    v_lshlrev_b32 v218, 16, v221
    v_and_b32 v219, s86, v221
    v_lshlrev_b32 v220, 16, v222
    v_and_b32 v221, s86, v222
    v_lshlrev_b32 v222, 16, v223
    v_and_b32_e64 v223, s86, v223
    s_waitcnt vmcnt(8)
    v_dot2_f32_bf16 v22, v108, s85, 0
    buffer_load_dwordx4 v8, s[44:47], s22 offen offset:1024 lds
    v_dot2_f32_bf16 v23, v108, v108, 0
    v_dot2_f32_bf16 v22, v109, s85, v22
    v_dot2_f32_bf16 v23, v109, v109, v23
    v_dot2_f32_bf16 v22, v110, s85, v22
    v_dot2_f32_bf16 v23, v110, v110, v23
    v_dot2_f32_bf16 v22, v111, s85, v22
    v_dot2_f32_bf16 v23, v111, v111, v23
    v_dot2_f32_bf16 v22, v148, s85, v22
    v_dot2_f32_bf16 v23, v148, v148, v23
    v_dot2_f32_bf16 v22, v149, s85, v22
    v_dot2_f32_bf16 v23, v149, v149, v23
    v_dot2_f32_bf16 v22, v150, s85, v22
    v_dot2_f32_bf16 v23, v150, v150, v23
    v_dot2_f32_bf16 v22, v151, s85, v22
    v_dot2_f32_bf16 v23, v151, v151, v23
    v_dot2_f32_bf16 v22, v188, s85, v22
    buffer_load_dwordx4 v8, s[44:47], s22 offen offset:2048 lds
    v_dot2_f32_bf16 v23, v188, v188, v23
    v_dot2_f32_bf16 v22, v189, s85, v22
    v_dot2_f32_bf16 v23, v189, v189, v23
    v_dot2_f32_bf16 v22, v190, s85, v22
    v_dot2_f32_bf16 v23, v190, v190, v23
    v_dot2_f32_bf16 v22, v191, s85, v22
    v_dot2_f32_bf16 v23, v191, v191, v23
    v_dot2_f32_bf16 v22, v228, s85, v22
    v_dot2_f32_bf16 v23, v228, v228, v23
    v_dot2_f32_bf16 v22, v229, s85, v22
    v_dot2_f32_bf16 v23, v229, v229, v23
    v_dot2_f32_bf16 v22, v230, s85, v22
    v_dot2_f32_bf16 v23, v230, v230, v23
    v_dot2_f32_bf16 v22, v231, s85, v22
    v_dot2_f32_bf16 v23, v231, v231, v23
    v_lshlrev_b32_e64 v104, 16, v108
    s_add_u32 m0, s20, 36864
    s_add_u32 s22, s21, 786432
    buffer_load_dwordx4 v8, s[44:47], s22 offen offset:0 lds
    v_and_b32 v105, s86, v108
    v_lshlrev_b32 v106, 16, v109
    v_and_b32 v107, s86, v109
    v_lshlrev_b32 v108, 16, v110
    v_and_b32 v109, s86, v110
    v_lshlrev_b32 v110, 16, v111
    v_and_b32 v111, s86, v111
    v_lshlrev_b32 v144, 16, v148
    v_and_b32 v145, s86, v148
    v_lshlrev_b32 v146, 16, v149
    v_and_b32 v147, s86, v149
    v_lshlrev_b32 v148, 16, v150
    v_and_b32 v149, s86, v150
    v_lshlrev_b32 v150, 16, v151
    v_and_b32 v151, s86, v151
    v_lshlrev_b32 v184, 16, v188
    buffer_load_dwordx4 v8, s[44:47], s22 offen offset:1024 lds
    v_and_b32 v185, s86, v188
    v_lshlrev_b32 v186, 16, v189
    v_and_b32 v187, s86, v189
    v_lshlrev_b32 v188, 16, v190
    v_and_b32 v189, s86, v190
    v_lshlrev_b32 v190, 16, v191
    v_and_b32 v191, s86, v191
    v_lshlrev_b32 v224, 16, v228
    v_and_b32 v225, s86, v228
    v_lshlrev_b32 v226, 16, v229
    v_and_b32 v227, s86, v229
    v_lshlrev_b32 v228, 16, v230
    v_and_b32 v229, s86, v230
    v_lshlrev_b32 v230, 16, v231
    v_and_b32 v231, s86, v231
    s_waitcnt vmcnt(8)
    v_dot2_f32_bf16 v24, v116, s85, 0
    buffer_load_dwordx4 v8, s[44:47], s22 offen offset:2048 lds
    v_dot2_f32_bf16 v25, v116, v116, 0
    v_dot2_f32_bf16 v24, v117, s85, v24
    v_dot2_f32_bf16 v25, v117, v117, v25
    v_dot2_f32_bf16 v24, v118, s85, v24
    v_dot2_f32_bf16 v25, v118, v118, v25
    v_dot2_f32_bf16 v24, v119, s85, v24
    v_dot2_f32_bf16 v25, v119, v119, v25
    v_dot2_f32_bf16 v24, v156, s85, v24
    v_dot2_f32_bf16 v25, v156, v156, v25
    v_dot2_f32_bf16 v24, v157, s85, v24
    v_dot2_f32_bf16 v25, v157, v157, v25
    v_dot2_f32_bf16 v24, v158, s85, v24
    v_dot2_f32_bf16 v25, v158, v158, v25
    v_dot2_f32_bf16 v24, v159, s85, v24
    v_dot2_f32_bf16 v25, v159, v159, v25
    v_dot2_f32_bf16 v24, v196, s85, v24
    s_add_u32 m0, s20, 49152
    s_add_u32 s22, s21, 1179648
    buffer_load_dwordx4 v8, s[44:47], s22 offen offset:0 lds
    v_dot2_f32_bf16 v25, v196, v196, v25
    v_dot2_f32_bf16 v24, v197, s85, v24
    v_dot2_f32_bf16 v25, v197, v197, v25
    v_dot2_f32_bf16 v24, v198, s85, v24
    v_dot2_f32_bf16 v25, v198, v198, v25
    v_dot2_f32_bf16 v24, v199, s85, v24
    v_dot2_f32_bf16 v25, v199, v199, v25
    v_dot2_f32_bf16 v24, v236, s85, v24
    v_dot2_f32_bf16 v25, v236, v236, v25
    v_dot2_f32_bf16 v24, v237, s85, v24
    v_dot2_f32_bf16 v25, v237, v237, v25
    v_dot2_f32_bf16 v24, v238, s85, v24
    v_dot2_f32_bf16 v25, v238, v238, v25
    v_dot2_f32_bf16 v24, v239, s85, v24
    v_dot2_f32_bf16 v25, v239, v239, v25
    s_lshl_b32 s12, s4, 3
    v_lshrrev_b32 v5, 2, v0
    buffer_load_dwordx4 v8, s[44:47], s22 offen offset:1024 lds
    v_lshlrev_b32 v5, 5, v5
    v_add_u32 v4, s12, v5
    v_add_f32_dpp v16, v16, v16 quad_perm:[1,0,3,2] row_mask:0xf bank_mask:0xf
    v_add_f32_dpp v17, v17, v17 quad_perm:[1,0,3,2] row_mask:0xf bank_mask:0xf
    v_add_f32_dpp v18, v18, v18 quad_perm:[1,0,3,2] row_mask:0xf bank_mask:0xf
    v_add_f32_dpp v19, v19, v19 quad_perm:[1,0,3,2] row_mask:0xf bank_mask:0xf
    v_add_f32_dpp v20, v20, v20 quad_perm:[1,0,3,2] row_mask:0xf bank_mask:0xf
    v_add_f32_dpp v21, v21, v21 quad_perm:[1,0,3,2] row_mask:0xf bank_mask:0xf
    v_add_f32_dpp v22, v22, v22 quad_perm:[1,0,3,2] row_mask:0xf bank_mask:0xf
    v_add_f32_dpp v23, v23, v23 quad_perm:[1,0,3,2] row_mask:0xf bank_mask:0xf
    v_add_f32_dpp v24, v24, v24 quad_perm:[1,0,3,2] row_mask:0xf bank_mask:0xf
    v_add_f32_dpp v25, v25, v25 quad_perm:[1,0,3,2] row_mask:0xf bank_mask:0xf
    v_add_f32_dpp v16, v16, v16 quad_perm:[2,3,0,1] row_mask:0xf bank_mask:0xf
    v_add_f32_dpp v17, v17, v17 quad_perm:[2,3,0,1] row_mask:0xf bank_mask:0xf
    v_add_f32_dpp v18, v18, v18 quad_perm:[2,3,0,1] row_mask:0xf bank_mask:0xf
    v_add_f32_dpp v19, v19, v19 quad_perm:[2,3,0,1] row_mask:0xf bank_mask:0xf
    v_add_f32_dpp v20, v20, v20 quad_perm:[2,3,0,1] row_mask:0xf bank_mask:0xf
    v_add_f32_dpp v21, v21, v21 quad_perm:[2,3,0,1] row_mask:0xf bank_mask:0xf
    v_add_f32_dpp v22, v22, v22 quad_perm:[2,3,0,1] row_mask:0xf bank_mask:0xf
    v_add_f32_dpp v23, v23, v23 quad_perm:[2,3,0,1] row_mask:0xf bank_mask:0xf
    v_add_f32_dpp v24, v24, v24 quad_perm:[2,3,0,1] row_mask:0xf bank_mask:0xf
    v_add_f32_dpp v25, v25, v25 quad_perm:[2,3,0,1] row_mask:0xf bank_mask:0xf
    s_mov_b32 s12, 0x11111111
    s_mov_b32 exec_lo, s12
    s_mov_b32 exec_hi, s12
    ds_write_b64 v4, v[16:17] offset:0
    ds_write_b64 v4, v[18:19] offset:512
    ds_write_b64 v4, v[20:21] offset:1024
    ds_write_b64 v4, v[22:23] offset:1536
    ds_write_b64 v4, v[24:25] offset:2048
    s_mov_b64 exec, -1
    v_lshlrev_b32 v112, 16, v116
    v_and_b32 v113, s86, v116
    v_lshlrev_b32 v114, 16, v117
    v_and_b32 v115, s86, v117
    v_lshlrev_b32 v116, 16, v118
    v_and_b32 v117, s86, v118
    v_lshlrev_b32 v118, 16, v119
    v_and_b32 v119, s86, v119
    v_lshlrev_b32 v152, 16, v156
    v_and_b32 v153, s86, v156
    v_lshlrev_b32 v154, 16, v157
    v_and_b32 v155, s86, v157
    v_lshlrev_b32 v156, 16, v158
    v_and_b32 v157, s86, v158
    v_lshlrev_b32 v158, 16, v159
    v_and_b32_e64 v159, s86, v159
    s_waitcnt lgkmcnt(0)
    s_barrier
    ds_read_b128 v[16:19], v5 offset:0
    ds_read_b128 v[20:23], v5 offset:16
    ds_read_b128 v[24:27], v5 offset:512
    ds_read_b128 v[28:31], v5 offset:528
    ds_read_b128 v[32:35], v5 offset:1024
    ds_read_b128 v[36:39], v5 offset:1040
    ds_read_b128 v[40:43], v5 offset:1536
    ds_read_b128 v[44:47], v5 offset:1552
    ds_read_b128 v[48:51], v5 offset:2048
    ds_read_b128 v[52:55], v5 offset:2064
    v_lshlrev_b32 v192, 16, v196
    v_and_b32 v193, s86, v196
    v_lshlrev_b32 v194, 16, v197
    v_and_b32 v195, s86, v197
    v_lshlrev_b32 v196, 16, v198
    v_and_b32 v197, s86, v198
    v_lshlrev_b32 v198, 16, v199
    v_and_b32 v199, s86, v199
    v_lshlrev_b32 v232, 16, v236
    v_and_b32 v233, s86, v236
    v_lshlrev_b32 v234, 16, v237
    v_and_b32 v235, s86, v237
    v_lshlrev_b32 v236, 16, v238
    v_and_b32 v237, s86, v238
    buffer_load_dwordx4 v8, s[44:47], s22 offen offset:2048 lds
    v_lshlrev_b32 v238, 16, v239
    v_and_b32_e64 v239, s86, v239
    s_waitcnt lgkmcnt(0)
    s_mov_b32 s12, 0x3b000000
    v_pk_add_f32 v[16:17], v[16:17], v[18:19]
    v_pk_add_f32 v[20:21], v[20:21], v[22:23]
    v_pk_add_f32 v[16:17], v[16:17], v[20:21]
    v_pk_mul_f32 v[16:17], v[16:17], s[12:13] op_sel_hi:[1,0]
    v_fma_f32 v17, -v16, v16, v17
    v_max_f32_e64 v17, 0, v17
    v_add_f32 v17, 0x3727c5ac, v17
    v_rsq_f32_e64 v64, v17
    v_pk_add_f32 v[24:25], v[24:25], v[26:27]
    v_pk_add_f32 v[28:29], v[28:29], v[30:31]
    v_pk_add_f32 v[24:25], v[24:25], v[28:29]
    buffer_load_dwordx4 v[240:243], v78, s[72:75], s24 offen sc1
    v_pk_mul_f32 v[24:25], v[24:25], s[12:13] op_sel_hi:[1,0]
    v_fma_f32 v25, -v24, v24, v25
    v_max_f32_e64 v25, 0, v25
    v_add_f32 v25, 0x3727c5ac, v25
    v_rsq_f32_e64 v66, v25
    v_pk_add_f32 v[32:33], v[32:33], v[34:35]
    v_pk_add_f32 v[36:37], v[36:37], v[38:39]
    v_pk_add_f32 v[32:33], v[32:33], v[36:37]
    v_pk_mul_f32 v[32:33], v[32:33], s[12:13] op_sel_hi:[1,0]
    v_fma_f32 v33, -v32, v32, v33
    v_max_f32_e64 v33, 0, v33
    v_add_f32 v33, 0x3727c5ac, v33
    v_rsq_f32_e64 v68, v33
    v_pk_add_f32 v[40:41], v[40:41], v[42:43]
    buffer_load_dwordx4 v[244:247], v78, s[72:75], s25 offen sc1
    v_pk_add_f32 v[44:45], v[44:45], v[46:47]
    v_pk_add_f32 v[40:41], v[40:41], v[44:45]
    v_pk_mul_f32 v[40:41], v[40:41], s[12:13] op_sel_hi:[1,0]
    v_fma_f32 v41, -v40, v40, v41
    v_max_f32_e64 v41, 0, v41
    v_add_f32 v41, 0x3727c5ac, v41
    v_rsq_f32_e64 v70, v41
    v_pk_add_f32 v[48:49], v[48:49], v[50:51]
    v_pk_add_f32 v[52:53], v[52:53], v[54:55]
    v_pk_add_f32 v[48:49], v[48:49], v[52:53]
    v_pk_mul_f32 v[48:49], v[48:49], s[12:13] op_sel_hi:[1,0]
    v_fma_f32 v49, -v48, v48, v49
    v_max_f32_e64 v49, 0, v49
    v_add_f32 v49, 0x3727c5ac, v49
    v_rsq_f32_e64 v72, v49
    buffer_load_dwordx4 v[248:251], v78, s[72:75], s26 offen sc1
    v_mul_f32 v65, -v16, v64
    v_mul_f32 v67, -v24, v66
    v_mul_f32 v69, -v32, v68
    v_mul_f32 v71, -v40, v70
    v_mul_f32 v73, -v48, v72
    v_pk_fma_f32 v[80:81], v[80:81], v[64:65], v[64:65] op_sel:[0,0,1] op_sel_hi:[1,0,1]
    v_pk_fma_f32 v[82:83], v[82:83], v[64:65], v[64:65] op_sel:[0,0,1] op_sel_hi:[1,0,1]
    v_pk_fma_f32 v[84:85], v[84:85], v[64:65], v[64:65] op_sel:[0,0,1] op_sel_hi:[1,0,1]
    v_pk_fma_f32 v[86:87], v[86:87], v[64:65], v[64:65] op_sel:[0,0,1] op_sel_hi:[1,0,1]
    v_pk_fma_f32 v[88:89], v[88:89], v[66:67], v[66:67] op_sel:[0,0,1] op_sel_hi:[1,0,1]
    v_pk_fma_f32 v[90:91], v[90:91], v[66:67], v[66:67] op_sel:[0,0,1] op_sel_hi:[1,0,1]
    v_pk_fma_f32 v[92:93], v[92:93], v[66:67], v[66:67] op_sel:[0,0,1] op_sel_hi:[1,0,1]
    v_pk_fma_f32 v[94:95], v[94:95], v[66:67], v[66:67] op_sel:[0,0,1] op_sel_hi:[1,0,1]
    v_pk_fma_f32 v[96:97], v[96:97], v[68:69], v[68:69] op_sel:[0,0,1] op_sel_hi:[1,0,1]
    v_pk_fma_f32 v[98:99], v[98:99], v[68:69], v[68:69] op_sel:[0,0,1] op_sel_hi:[1,0,1]
    v_pk_fma_f32 v[100:101], v[100:101], v[68:69], v[68:69] op_sel:[0,0,1] op_sel_hi:[1,0,1]
    buffer_load_dwordx4 v[252:255], v78, s[72:75], s27 offen sc1
    v_pk_fma_f32 v[102:103], v[102:103], v[68:69], v[68:69] op_sel:[0,0,1] op_sel_hi:[1,0,1]
    v_pk_fma_f32 v[104:105], v[104:105], v[70:71], v[70:71] op_sel:[0,0,1] op_sel_hi:[1,0,1]
    v_pk_fma_f32 v[106:107], v[106:107], v[70:71], v[70:71] op_sel:[0,0,1] op_sel_hi:[1,0,1]
    v_pk_fma_f32 v[108:109], v[108:109], v[70:71], v[70:71] op_sel:[0,0,1] op_sel_hi:[1,0,1]
    v_pk_fma_f32 v[110:111], v[110:111], v[70:71], v[70:71] op_sel:[0,0,1] op_sel_hi:[1,0,1]
    v_pk_fma_f32 v[112:113], v[112:113], v[72:73], v[72:73] op_sel:[0,0,1] op_sel_hi:[1,0,1]
    v_pk_fma_f32 v[114:115], v[114:115], v[72:73], v[72:73] op_sel:[0,0,1] op_sel_hi:[1,0,1]
    v_pk_fma_f32 v[116:117], v[116:117], v[72:73], v[72:73] op_sel:[0,0,1] op_sel_hi:[1,0,1]
    v_pk_fma_f32 v[118:119], v[118:119], v[72:73], v[72:73] op_sel:[0,0,1] op_sel_hi:[1,0,1]
    v_pk_fma_f32 v[120:121], v[120:121], v[64:65], v[64:65] op_sel:[0,0,1] op_sel_hi:[1,0,1]
    v_pk_fma_f32 v[122:123], v[122:123], v[64:65], v[64:65] op_sel:[0,0,1] op_sel_hi:[1,0,1]
    v_pk_fma_f32 v[124:125], v[124:125], v[64:65], v[64:65] op_sel:[0,0,1] op_sel_hi:[1,0,1]
    v_pk_fma_f32 v[126:127], v[126:127], v[64:65], v[64:65] op_sel:[0,0,1] op_sel_hi:[1,0,1]
    v_pk_fma_f32 v[128:129], v[128:129], v[66:67], v[66:67] op_sel:[0,0,1] op_sel_hi:[1,0,1]
    v_pk_fma_f32 v[130:131], v[130:131], v[66:67], v[66:67] op_sel:[0,0,1] op_sel_hi:[1,0,1]
    v_pk_fma_f32 v[132:133], v[132:133], v[66:67], v[66:67] op_sel:[0,0,1] op_sel_hi:[1,0,1]
    s_add_u32 m0, s20, 61440
    s_add_u32 s22, s21, 98304
    buffer_load_dwordx4 v8, s[44:47], s22 offen offset:0 lds
    v_pk_fma_f32 v[134:135], v[134:135], v[66:67], v[66:67] op_sel:[0,0,1] op_sel_hi:[1,0,1]
    v_pk_fma_f32 v[136:137], v[136:137], v[68:69], v[68:69] op_sel:[0,0,1] op_sel_hi:[1,0,1]
    v_pk_fma_f32 v[138:139], v[138:139], v[68:69], v[68:69] op_sel:[0,0,1] op_sel_hi:[1,0,1]
    v_pk_fma_f32 v[140:141], v[140:141], v[68:69], v[68:69] op_sel:[0,0,1] op_sel_hi:[1,0,1]
    v_pk_fma_f32 v[142:143], v[142:143], v[68:69], v[68:69] op_sel:[0,0,1] op_sel_hi:[1,0,1]
    v_pk_fma_f32 v[144:145], v[144:145], v[70:71], v[70:71] op_sel:[0,0,1] op_sel_hi:[1,0,1]
    v_pk_fma_f32 v[146:147], v[146:147], v[70:71], v[70:71] op_sel:[0,0,1] op_sel_hi:[1,0,1]
    v_pk_fma_f32 v[148:149], v[148:149], v[70:71], v[70:71] op_sel:[0,0,1] op_sel_hi:[1,0,1]
    v_pk_fma_f32 v[150:151], v[150:151], v[70:71], v[70:71] op_sel:[0,0,1] op_sel_hi:[1,0,1]
    v_pk_fma_f32 v[152:153], v[152:153], v[72:73], v[72:73] op_sel:[0,0,1] op_sel_hi:[1,0,1]
    v_pk_fma_f32 v[154:155], v[154:155], v[72:73], v[72:73] op_sel:[0,0,1] op_sel_hi:[1,0,1]
    v_pk_fma_f32 v[156:157], v[156:157], v[72:73], v[72:73] op_sel:[0,0,1] op_sel_hi:[1,0,1]
    v_pk_fma_f32 v[158:159], v[158:159], v[72:73], v[72:73] op_sel:[0,0,1] op_sel_hi:[1,0,1]
    buffer_load_dwordx4 v8, s[44:47], s22 offen offset:1024 lds
    buffer_load_dwordx4 v8, s[44:47], s22 offen offset:2048 lds
    s_add_u32 m0, s20, 73728
    s_add_u32 s22, s21, 491520
    buffer_load_dwordx4 v8, s[44:47], s22 offen offset:0 lds
    buffer_load_dwordx4 v8, s[44:47], s22 offen offset:1024 lds
    buffer_load_dwordx4 v8, s[44:47], s22 offen offset:2048 lds
    s_add_u32 m0, s20, 86016
    s_add_u32 s22, s21, 884736
    buffer_load_dwordx4 v8, s[44:47], s22 offen offset:0 lds
    s_waitcnt vmcnt(11)
    s_barrier
    ds_read_b64_tr_b16 a[0:1], v9 offset:0
    ds_read_b64_tr_b16 a[2:3], v9 offset:512
    ds_read_b64_tr_b16 a[4:5], v9 offset:1024
    ds_read_b64_tr_b16 a[6:7], v9 offset:1536
    ds_read_b64_tr_b16 a[8:9], v9 offset:2048
    ds_read_b64_tr_b16 a[10:11], v9 offset:2560
    v_pk_fma_f32 v[160:161], v[160:161], v[64:65], v[64:65] op_sel:[0,0,1] op_sel_hi:[1,0,1]
    v_pk_fma_f32 v[162:163], v[162:163], v[64:65], v[64:65] op_sel:[0,0,1] op_sel_hi:[1,0,1]
    v_pk_fma_f32 v[164:165], v[164:165], v[64:65], v[64:65] op_sel:[0,0,1] op_sel_hi:[1,0,1]
    v_pk_fma_f32 v[166:167], v[166:167], v[64:65], v[64:65] op_sel:[0,0,1] op_sel_hi:[1,0,1]
    ds_read_b64_tr_b16 a[12:13], v9 offset:12288
    ds_read_b64_tr_b16 a[14:15], v9 offset:12800
    ds_read_b64_tr_b16 a[16:17], v9 offset:13312
    ds_read_b64_tr_b16 a[18:19], v9 offset:13824
    ds_read_b64_tr_b16 a[20:21], v9 offset:14336
    ds_read_b64_tr_b16 a[22:23], v9 offset:14848
    v_pk_fma_f32 v[168:169], v[168:169], v[66:67], v[66:67] op_sel:[0,0,1] op_sel_hi:[1,0,1]
    buffer_load_dwordx4 v8, s[44:47], s22 offen offset:1024 lds
    v_pk_fma_f32 v[170:171], v[170:171], v[66:67], v[66:67] op_sel:[0,0,1] op_sel_hi:[1,0,1]
    v_pk_fma_f32 v[172:173], v[172:173], v[66:67], v[66:67] op_sel:[0,0,1] op_sel_hi:[1,0,1]
    v_pk_fma_f32 v[174:175], v[174:175], v[66:67], v[66:67] op_sel:[0,0,1] op_sel_hi:[1,0,1]
    ds_read_b64_tr_b16 a[24:25], v9 offset:24576
    ds_read_b64_tr_b16 a[26:27], v9 offset:25088
    ds_read_b64_tr_b16 a[28:29], v9 offset:25600
    ds_read_b64_tr_b16 a[30:31], v9 offset:26112
    ds_read_b64_tr_b16 a[32:33], v9 offset:26624
    ds_read_b64_tr_b16 a[34:35], v9 offset:27136
    v_pk_fma_f32 v[176:177], v[176:177], v[68:69], v[68:69] op_sel:[0,0,1] op_sel_hi:[1,0,1]
    v_pk_fma_f32 v[178:179], v[178:179], v[68:69], v[68:69] op_sel:[0,0,1] op_sel_hi:[1,0,1]
    v_pk_fma_f32 v[180:181], v[180:181], v[68:69], v[68:69] op_sel:[0,0,1] op_sel_hi:[1,0,1]
    v_pk_fma_f32 v[182:183], v[182:183], v[68:69], v[68:69] op_sel:[0,0,1] op_sel_hi:[1,0,1]
    ds_read_b64_tr_b16 a[36:37], v9 offset:36864
    buffer_load_dwordx4 v8, s[44:47], s22 offen offset:2048 lds
    ds_read_b64_tr_b16 a[38:39], v9 offset:37376
    ds_read_b64_tr_b16 a[40:41], v9 offset:37888
    ds_read_b64_tr_b16 a[42:43], v9 offset:38400
    ds_read_b64_tr_b16 a[44:45], v9 offset:38912
    ds_read_b64_tr_b16 a[46:47], v9 offset:39424
    v_pk_fma_f32 v[184:185], v[184:185], v[70:71], v[70:71] op_sel:[0,0,1] op_sel_hi:[1,0,1]
    v_pk_fma_f32 v[186:187], v[186:187], v[70:71], v[70:71] op_sel:[0,0,1] op_sel_hi:[1,0,1]
    v_pk_fma_f32 v[188:189], v[188:189], v[70:71], v[70:71] op_sel:[0,0,1] op_sel_hi:[1,0,1]
    v_pk_fma_f32 v[190:191], v[190:191], v[70:71], v[70:71] op_sel:[0,0,1] op_sel_hi:[1,0,1]
    s_add_u32 m0, s20, 98304
    s_add_u32 s22, s21, 1277952
    buffer_load_dwordx4 v8, s[44:47], s22 offen offset:0 lds
    buffer_load_dwordx4 v8, s[44:47], s22 offen offset:1024 lds
    s_waitcnt vmcnt(11)
    s_branch L_c_6
L_p_7:
    buffer_load_dwordx4 v[240:243], v78, s[72:75], s24 offen sc1
    buffer_load_dwordx4 v[244:247], v78, s[72:75], s25 offen sc1
    buffer_load_dwordx4 v[248:251], v78, s[72:75], s26 offen sc1
    buffer_load_dwordx4 v[252:255], v78, s[72:75], s27 offen sc1
    s_waitcnt vmcnt(0)
L_c_6:
    s_and_b32 s13, s8, 0xff
    v_xor_b32 v240, s13, v240
    v_xor_b32 v241, s13, v241
    v_xor_b32 v242, s13, v242
    v_xor_b32 v243, s13, v243
    v_xor_b32 v244, s13, v244
    v_xor_b32 v245, s13, v245
    v_xor_b32 v246, s13, v246
    v_xor_b32 v247, s13, v247
    v_xor_b32 v248, s13, v248
    v_xor_b32 v249, s13, v249
    v_xor_b32 v250, s13, v250
    v_xor_b32 v251, s13, v251
    v_xor_b32 v252, s13, v252
    v_xor_b32 v253, s13, v253
    v_xor_b32 v254, s13, v254
    v_xor_b32_e64 v255, s13, v255
    v_or3_b32 v5, v240, v241, v242
    v_or3_b32 v6, v243, v244, v245
    v_or3_b32 v5, v5, v246, v247
    v_or3_b32 v6, v6, v248, v249
    v_or3_b32 v5, v5, v250, v251
    v_or3_b32 v6, v6, v252, v253
    v_or3_b32 v5, v5, v254, v255
    v_or_b32_e64 v5, v5, v6
    v_and_b32 v5, 0xff, v5
    v_cmp_ne_u32_e64 vcc, 0, v5
    s_nop 1
    s_cbranch_vccz L_d_8
    s_sub_u32 s87, s87, 1
    s_cmp_eq_u32 s87, 0
    s_cbranch_scc1 L_giveup
    s_branch L_p_7
L_d_8:
    v_pk_add_f32 v[240:241], v[240:241], v[244:245]
    buffer_load_dwordx4 v8, s[44:47], s22 offen offset:2048 lds
    v_pk_add_f32 v[248:249], v[248:249], v[252:253]
    v_pk_add_f32 v[242:243], v[242:243], v[246:247]
    v_pk_add_f32 v[250:251], v[250:251], v[254:255]
    v_pk_add_f32 v[240:241], v[240:241], v[248:249]
    v_pk_add_f32 v[242:243], v[242:243], v[250:251]
    v_cvt_pk_bf16_f32 v5, v240, v241
    v_cvt_pk_bf16_f32 v6, v242, v243
    v_lshlrev_b32 v240, 16, v5
    v_and_b32 v241, s86, v5
    v_lshlrev_b32 v242, 16, v6
    v_and_b32 v243, s86, v6
    v_add_f32 v240, v240, v79
    v_add_f32 v241, v241, v79
    v_add_f32 v242, v242, v79
    v_add_f32 v243, v243, v79
    v_cvt_pk_bf16_f32 v5, v240, v241
    s_add_u32 m0, s20, 110592
    s_add_u32 s22, s21, 196608
    buffer_load_dwordx4 v8, s[44:47], s22 offen offset:0 lds
    v_cvt_pk_bf16_f32 v6, v242, v243
    v_lshlrev_b32 v240, 16, v5
    v_and_b32 v241, s86, v5
    v_lshlrev_b32 v242, 16, v6
    v_and_b32 v243, s86, v6
    ds_write_b128 v76, v[240:243]
    ds_read_b128 v[16:19], v12 offset:0
    ds_read_b128 v[24:27], v12 offset:512
    ds_read_b128 v[20:23], v12 offset:16
    ds_read_b128 v[28:31], v12 offset:528
    v_pk_fma_f32 v[192:193], v[192:193], v[72:73], v[72:73] op_sel:[0,0,1] op_sel_hi:[1,0,1]
    buffer_load_dwordx4 v8, s[44:47], s22 offen offset:1024 lds
    v_pk_fma_f32 v[194:195], v[194:195], v[72:73], v[72:73] op_sel:[0,0,1] op_sel_hi:[1,0,1]
    v_pk_fma_f32 v[196:197], v[196:197], v[72:73], v[72:73] op_sel:[0,0,1] op_sel_hi:[1,0,1]
    v_pk_fma_f32 v[198:199], v[198:199], v[72:73], v[72:73] op_sel:[0,0,1] op_sel_hi:[1,0,1]
    v_pk_fma_f32 v[200:201], v[200:201], v[64:65], v[64:65] op_sel:[0,0,1] op_sel_hi:[1,0,1]
    v_pk_fma_f32 v[202:203], v[202:203], v[64:65], v[64:65] op_sel:[0,0,1] op_sel_hi:[1,0,1]
    v_pk_fma_f32 v[204:205], v[204:205], v[64:65], v[64:65] op_sel:[0,0,1] op_sel_hi:[1,0,1]
    v_pk_fma_f32 v[206:207], v[206:207], v[64:65], v[64:65] op_sel:[0,0,1] op_sel_hi:[1,0,1]
    v_pk_fma_f32 v[208:209], v[208:209], v[66:67], v[66:67] op_sel:[0,0,1] op_sel_hi:[1,0,1]
    v_pk_fma_f32 v[210:211], v[210:211], v[66:67], v[66:67] op_sel:[0,0,1] op_sel_hi:[1,0,1]
    v_pk_fma_f32 v[212:213], v[212:213], v[66:67], v[66:67] op_sel:[0,0,1] op_sel_hi:[1,0,1]
    v_pk_fma_f32 v[214:215], v[214:215], v[66:67], v[66:67] op_sel:[0,0,1] op_sel_hi:[1,0,1]
    v_pk_fma_f32 v[216:217], v[216:217], v[68:69], v[68:69] op_sel:[0,0,1] op_sel_hi:[1,0,1]
    v_pk_fma_f32 v[218:219], v[218:219], v[68:69], v[68:69] op_sel:[0,0,1] op_sel_hi:[1,0,1]
    v_pk_fma_f32 v[220:221], v[220:221], v[68:69], v[68:69] op_sel:[0,0,1] op_sel_hi:[1,0,1]
    v_pk_fma_f32 v[222:223], v[222:223], v[68:69], v[68:69] op_sel:[0,0,1] op_sel_hi:[1,0,1]
    v_pk_fma_f32 v[224:225], v[224:225], v[70:71], v[70:71] op_sel:[0,0,1] op_sel_hi:[1,0,1]
    buffer_load_dwordx4 v8, s[44:47], s22 offen offset:2048 lds
    v_pk_fma_f32 v[226:227], v[226:227], v[70:71], v[70:71] op_sel:[0,0,1] op_sel_hi:[1,0,1]
    v_pk_fma_f32 v[228:229], v[228:229], v[70:71], v[70:71] op_sel:[0,0,1] op_sel_hi:[1,0,1]
    v_pk_fma_f32 v[230:231], v[230:231], v[70:71], v[70:71] op_sel:[0,0,1] op_sel_hi:[1,0,1]
    v_pk_fma_f32 v[232:233], v[232:233], v[72:73], v[72:73] op_sel:[0,0,1] op_sel_hi:[1,0,1]
    v_pk_fma_f32 v[234:235], v[234:235], v[72:73], v[72:73] op_sel:[0,0,1] op_sel_hi:[1,0,1]
    v_pk_fma_f32 v[236:237], v[236:237], v[72:73], v[72:73] op_sel:[0,0,1] op_sel_hi:[1,0,1]
    v_pk_fma_f32 v[238:239], v[238:239], v[72:73], v[72:73] op_sel:[0,0,1] op_sel_hi:[1,0,1]
    s_waitcnt lgkmcnt(0)
    s_barrier
    v_pk_fma_f32 v[80:81], v[80:81], v[24:25], v[16:17]
    v_pk_fma_f32 v[82:83], v[82:83], v[26:27], v[18:19]
    v_pk_fma_f32 v[84:85], v[84:85], v[28:29], v[20:21]
    v_pk_fma_f32 v[86:87], v[86:87], v[30:31], v[22:23]
    v_cvt_pk_bf16_f32 v80, v80, v81
    v_cvt_pk_bf16_f32 v81, v82, v83
    v_cvt_pk_bf16_f32 v82, v84, v85
    s_add_u32 m0, s20, 122880
    s_add_u32 s22, s21, 589824
    buffer_load_dwordx4 v8, s[44:47], s22 offen offset:0 lds
    v_cvt_pk_bf16_f32 v83, v86, v87
    ds_write_b128 v13, v[80:83] offset:0
    v_pk_fma_f32 v[88:89], v[88:89], v[24:25], v[16:17]
    v_pk_fma_f32 v[90:91], v[90:91], v[26:27], v[18:19]
    v_pk_fma_f32 v[92:93], v[92:93], v[28:29], v[20:21]
    v_pk_fma_f32 v[94:95], v[94:95], v[30:31], v[22:23]
    v_cvt_pk_bf16_f32 v88, v88, v89
    v_cvt_pk_bf16_f32 v89, v90, v91
    v_cvt_pk_bf16_f32 v90, v92, v93
    v_cvt_pk_bf16_f32 v91, v94, v95
    ds_write_b128 v13, v[88:91] offset:1024
    buffer_load_dwordx4 v8, s[44:47], s22 offen offset:1024 lds
    v_pk_fma_f32 v[96:97], v[96:97], v[24:25], v[16:17]
    v_pk_fma_f32 v[98:99], v[98:99], v[26:27], v[18:19]
    v_pk_fma_f32 v[100:101], v[100:101], v[28:29], v[20:21]
    v_pk_fma_f32 v[102:103], v[102:103], v[30:31], v[22:23]
    v_cvt_pk_bf16_f32 v96, v96, v97
    v_cvt_pk_bf16_f32 v97, v98, v99
    v_cvt_pk_bf16_f32 v98, v100, v101
    v_cvt_pk_bf16_f32 v99, v102, v103
    ds_write_b128 v13, v[96:99] offset:2048
    v_pk_fma_f32 v[104:105], v[104:105], v[24:25], v[16:17]
    v_pk_fma_f32 v[106:107], v[106:107], v[26:27], v[18:19]
    buffer_load_dwordx4 v8, s[44:47], s22 offen offset:2048 lds
    v_pk_fma_f32 v[108:109], v[108:109], v[28:29], v[20:21]
    v_pk_fma_f32 v[110:111], v[110:111], v[30:31], v[22:23]
    v_cvt_pk_bf16_f32 v104, v104, v105
    v_cvt_pk_bf16_f32 v105, v106, v107
    v_cvt_pk_bf16_f32 v106, v108, v109
    v_cvt_pk_bf16_f32 v107, v110, v111
    ds_write_b128 v13, v[104:107] offset:3072
    v_pk_fma_f32 v[112:113], v[112:113], v[24:25], v[16:17]
    v_pk_fma_f32 v[114:115], v[114:115], v[26:27], v[18:19]
    v_pk_fma_f32 v[116:117], v[116:117], v[28:29], v[20:21]
    v_pk_fma_f32 v[118:119], v[118:119], v[30:31], v[22:23]
    v_cvt_pk_bf16_f32 v112, v112, v113
    v_cvt_pk_bf16_f32 v113, v114, v115
    v_cvt_pk_bf16_f32 v114, v116, v117
    v_cvt_pk_bf16_f32 v115, v118, v119
    ds_write_b128 v13, v[112:115] offset:4096
    ds_read_b128 v[64:67], v12 offset:128
    ds_read_b128 v[72:75], v12 offset:640
    ds_read_b128 v[68:71], v12 offset:144
    ds_read_b128 v[76:79], v12 offset:656
    s_add_u32 m0, s20, 135168
    s_add_u32 s22, s21, 983040
    buffer_load_dwordx4 v8, s[44:47], s22 offen offset:0 lds
    buffer_load_dwordx4 v8, s[44:47], s22 offen offset:1024 lds
    buffer_load_dwordx4 v8, s[44:47], s22 offen offset:2048 lds
    s_add_u32 m0, s20, 147456
    s_add_u32 s22, s21, 1376256
    buffer_load_dwordx4 v8, s[44:47], s22 offen offset:0 lds
    buffer_load_dwordx4 v8, s[44:47], s22 offen offset:1024 lds
    s_waitcnt vmcnt(11)
    s_waitcnt lgkmcnt(4)
    s_barrier
    v_accvgpr_read_b32 v81, a251
    v_accvgpr_read_b32 v86, a254
    v_accvgpr_read_b32 v87, a255
    ds_read_b128 a[192:195], v14 offset:0
    ds_read_b128 a[196:199], v14 offset:1024
    ds_read_b128 a[200:203], v14 offset:2048
    ds_read_b128 a[204:207], v14 offset:3072
    ds_read_b128 a[208:211], v14 offset:4096
    v_add_u32 v9, 49152, v9
    s_waitcnt lgkmcnt(0)
    v_mfma_f32_16x16x32_bf16 v[16:19], a[0:3], a[192:195], 0
    ds_read_b128 a[212:215], v14 offset:5120
    v_fma_f32 v120, v120, v72, v64
    v_mfma_f32_16x16x32_bf16 v[32:35], a[4:7], a[192:195], 0
    buffer_load_dwordx4 v8, s[44:47], s22 offen offset:2048 lds
    ds_read_b128 a[216:219], v14 offset:6144
    v_fma_f32 v121, v121, v73, v65
    v_fma_f32 v122, v122, v74, v66
    v_mfma_f32_16x16x32_bf16 v[240:243], a[192:195], a[8:11], 0
    ds_read_b128 a[220:223], v14 offset:7168
    v_fma_f32 v123, v123, v75, v67
    v_fma_f32 v124, v124, v76, v68
    v_mfma_f32_16x16x32_bf16 v[20:23], a[0:3], a[196:199], 0
    ds_read_b128 a[224:227], v14 offset:8192
    v_fma_f32 v125, v125, v77, v69
    v_fma_f32 v126, v126, v78, v70
    v_mfma_f32_16x16x32_bf16 v[36:39], a[4:7], a[196:199], 0
    ds_read_b128 a[228:231], v14 offset:9216
    v_fma_f32 v127, v127, v79, v71
    v_cvt_pk_bf16_f32 v120, v120, v121
    v_mfma_f32_16x16x32_bf16 v[244:247], a[196:199], a[8:11], 0
    buffer_load_dwordx2 v[112:113], v87, s[76:79], s33 offen
    ds_read_b64_tr_b16 a[48:49], v9 offset:0
    v_cvt_pk_bf16_f32 v121, v122, v123
    v_cvt_pk_bf16_f32 v122, v124, v125
    v_mfma_f32_16x16x32_bf16 v[24:27], a[0:3], a[200:203], 0
    ds_read_b64_tr_b16 a[50:51], v9 offset:512
    v_cvt_pk_bf16_f32 v123, v126, v127
    v_mfma_f32_16x16x32_bf16 v[40:43], a[4:7], a[200:203], 0
    ds_read_b64_tr_b16 a[52:53], v9 offset:1024
    ds_write_b128 v13, v[120:123] offset:20480
    v_mfma_f32_16x16x32_bf16 v[248:251], a[200:203], a[8:11], 0
    buffer_load_dwordx4 v[96:99], v86, s[64:67], s29 offen
    ds_read_b64_tr_b16 a[54:55], v9 offset:1536
    v_fma_f32 v128, v128, v72, v64
    v_fma_f32 v129, v129, v73, v65
    v_mfma_f32_16x16x32_bf16 v[28:31], a[0:3], a[204:207], 0
    ds_read_b64_tr_b16 a[56:57], v9 offset:2048
    v_fma_f32 v130, v130, v74, v66
    v_fma_f32 v131, v131, v75, v67
    v_mfma_f32_16x16x32_bf16 v[44:47], a[4:7], a[204:207], 0
    ds_read_b64_tr_b16 a[58:59], v9 offset:2560
    v_fma_f32 v132, v132, v76, v68
    v_fma_f32 v133, v133, v77, v69
    v_mfma_f32_16x16x32_bf16 v[252:255], a[204:207], a[8:11], 0
    ds_read_b64_tr_b16 a[60:61], v9 offset:12288
    v_fma_f32 v134, v134, v78, v70
    v_fma_f32 v135, v135, v79, v71
    v_mfma_f32_16x16x32_bf16 v[48:51], a[4:7], a[208:211], 0
    buffer_load_dwordx4 v[100:103], v86, s[64:67], s30 offen
    ds_read_b64_tr_b16 a[62:63], v9 offset:12800
    v_cvt_pk_bf16_f32 v128, v128, v129
    v_cvt_pk_bf16_f32 v129, v130, v131
    v_mfma_f32_16x16x32_bf16 v[52:55], a[208:211], a[8:11], 0
    v_cvt_pk_bf16_f32 v130, v132, v133
    v_cvt_pk_bf16_f32 v131, v134, v135
    s_waitcnt lgkmcnt(9)
    v_mfma_f32_16x16x32_bf16 v[16:19], a[12:15], a[212:215], v[16:19]
    ds_read_b128 a[192:195], v14 offset:10240
    v_mfma_f32_16x16x32_bf16 v[32:35], a[16:19], a[212:215], v[32:35]
    ds_read_b128 a[196:199], v14 offset:11264
    ds_write_b128 v13, v[128:131] offset:21504
    buffer_load_dwordx4 v[104:107], v86, s[64:67], s31 offen
    v_fma_f32 v136, v136, v72, v64
    v_mfma_f32_16x16x32_bf16 v[240:243], a[212:215], a[20:23], v[240:243]
    ds_read_b128 a[200:203], v14 offset:12288
    v_fma_f32 v137, v137, v73, v65
    v_fma_f32 v138, v138, v74, v66
    v_mfma_f32_16x16x32_bf16 v[20:23], a[12:15], a[216:219], v[20:23]
    ds_read_b128 a[204:207], v14 offset:13312
    v_fma_f32 v139, v139, v75, v67
    v_fma_f32 v140, v140, v76, v68
    v_mfma_f32_16x16x32_bf16 v[36:39], a[16:19], a[216:219], v[36:39]
    ds_read_b128 a[208:211], v14 offset:14336
    v_fma_f32 v141, v141, v77, v69
    v_fma_f32 v142, v142, v78, v70
    v_mfma_f32_16x16x32_bf16 v[244:247], a[216:219], a[20:23], v[244:247]
    buffer_load_dwordx4 v[108:111], v86, s[64:67], s32 offen
    ds_read_b64_tr_b16 a[64:65], v9 offset:13312
    v_fma_f32 v143, v143, v79, v71
    v_cvt_pk_bf16_f32 v136, v136, v137
    v_mfma_f32_16x16x32_bf16 v[24:27], a[12:15], a[220:223], v[24:27]
    ds_read_b64_tr_b16 a[66:67], v9 offset:13824
    v_cvt_pk_bf16_f32 v137, v138, v139
    v_cvt_pk_bf16_f32 v138, v140, v141
    v_mfma_f32_16x16x32_bf16 v[40:43], a[16:19], a[220:223], v[40:43]
    ds_read_b64_tr_b16 a[68:69], v9 offset:14336
    v_cvt_pk_bf16_f32 v139, v142, v143
    v_mfma_f32_16x16x32_bf16 v[248:251], a[220:223], a[20:23], v[248:251]
    ds_read_b64_tr_b16 a[70:71], v9 offset:14848
    ds_write_b128 v13, v[136:139] offset:22528
    s_mov_b32 s22, 0
    buffer_load_dword v10, v11, s[48:51], s22 offen
    v_mfma_f32_16x16x32_bf16 v[28:31], a[12:15], a[224:227], v[28:31]
    ds_read_b64_tr_b16 a[72:73], v9 offset:24576
    v_fma_f32 v144, v144, v72, v64
    v_fma_f32 v145, v145, v73, v65
    v_mfma_f32_16x16x32_bf16 v[44:47], a[16:19], a[224:227], v[44:47]
    ds_read_b64_tr_b16 a[74:75], v9 offset:25088
    v_fma_f32 v146, v146, v74, v66
    v_fma_f32 v147, v147, v75, v67
    v_mfma_f32_16x16x32_bf16 v[252:255], a[224:227], a[20:23], v[252:255]
    ds_read_b64_tr_b16 a[76:77], v9 offset:25600
    v_fma_f32 v148, v148, v76, v68
    v_fma_f32 v149, v149, v77, v69
    v_mfma_f32_16x16x32_bf16 v[48:51], a[16:19], a[228:231], v[48:51]
    s_mov_b32 s22, 0
    buffer_load_dword v10, v11, s[52:55], s22 offen
    ds_read_b64_tr_b16 a[78:79], v9 offset:26112
    v_fma_f32 v150, v150, v78, v70
    v_fma_f32 v151, v151, v79, v71
    v_mfma_f32_16x16x32_bf16 v[52:55], a[228:231], a[20:23], v[52:55]
    v_cvt_pk_bf16_f32 v144, v144, v145
    v_cvt_pk_bf16_f32 v145, v146, v147
    s_waitcnt lgkmcnt(9)
    v_mfma_f32_16x16x32_bf16 v[16:19], a[24:27], a[192:195], v[16:19]
    ds_read_b128 a[212:215], v14 offset:15360
    v_cvt_pk_bf16_f32 v146, v148, v149
    v_cvt_pk_bf16_f32 v147, v150, v151
    v_mfma_f32_16x16x32_bf16 v[32:35], a[28:31], a[192:195], v[32:35]
    ds_read_b128 a[216:219], v14 offset:16384
    v_mfma_f32_16x16x32_bf16 v[240:243], a[192:195], a[32:35], v[240:243]
    s_mov_b32 s22, 0
    buffer_load_dword v10, v11, s[56:59], s22 offen
    ds_read_b128 a[220:223], v14 offset:17408
    ds_write_b128 v13, v[144:147] offset:23552
    v_fma_f32 v152, v152, v72, v64
    v_mfma_f32_16x16x32_bf16 v[20:23], a[24:27], a[196:199], v[20:23]
    ds_read_b128 a[224:227], v14 offset:18432
    v_fma_f32 v153, v153, v73, v65
    v_fma_f32 v154, v154, v74, v66
    v_mfma_f32_16x16x32_bf16 v[36:39], a[28:31], a[196:199], v[36:39]
    ds_read_b128 a[228:231], v14 offset:19456
    v_fma_f32 v155, v155, v75, v67
    v_fma_f32 v156, v156, v76, v68
    v_mfma_f32_16x16x32_bf16 v[244:247], a[196:199], a[32:35], v[244:247]
    s_sub_u32 s22, 0x180, s48
    s_and_b32 s22, s22, 0x380
    s_add_u32 s22, s22, 0
    buffer_load_dword v10, v81, s[48:51], s22 offen
    ds_read_b64_tr_b16 a[80:81], v9 offset:26624
    v_fma_f32 v157, v157, v77, v69
    v_fma_f32 v158, v158, v78, v70
    v_mfma_f32_16x16x32_bf16 v[24:27], a[24:27], a[200:203], v[24:27]
    ds_read_b64_tr_b16 a[82:83], v9 offset:27136
    v_fma_f32 v159, v159, v79, v71
    v_cvt_pk_bf16_f32 v152, v152, v153
    v_mfma_f32_16x16x32_bf16 v[40:43], a[28:31], a[200:203], v[40:43]
    ds_read_b64_tr_b16 a[84:85], v9 offset:36864
    v_cvt_pk_bf16_f32 v153, v154, v155
    v_cvt_pk_bf16_f32 v154, v156, v157
    v_mfma_f32_16x16x32_bf16 v[248:251], a[200:203], a[32:35], v[248:251]
    ds_read_b64_tr_b16 a[86:87], v9 offset:37376
    v_cvt_pk_bf16_f32 v155, v158, v159
    v_mfma_f32_16x16x32_bf16 v[28:31], a[24:27], a[204:207], v[28:31]
    ds_read_b64_tr_b16 a[88:89], v9 offset:37888
    ds_write_b128 v13, v[152:155] offset:24576
    v_mfma_f32_16x16x32_bf16 v[44:47], a[28:31], a[204:207], v[44:47]
    ds_read_b64_tr_b16 a[90:91], v9 offset:38400
    ds_read_b128 v[64:67], v12 offset:256
    ds_read_b128 v[72:75], v12 offset:768
    v_mfma_f32_16x16x32_bf16 v[252:255], a[204:207], a[32:35], v[252:255]
    ds_read_b64_tr_b16 a[92:93], v9 offset:38912
    ds_read_b128 v[68:71], v12 offset:272
    ds_read_b128 v[76:79], v12 offset:784
    v_mfma_f32_16x16x32_bf16 v[48:51], a[28:31], a[208:211], v[48:51]
    ds_read_b64_tr_b16 a[94:95], v9 offset:39424
    v_mfma_f32_16x16x32_bf16 v[52:55], a[208:211], a[32:35], v[52:55]
    s_waitcnt vmcnt(9)
    s_waitcnt lgkmcnt(0)
    s_barrier
    v_add_u32 v9, 49152, v9
    s_add_u32 m0, s20, 61440
    s_add_u32 s22, s21, 294912
    buffer_load_dwordx4 v8, s[44:47], s22 offen offset:0 lds
    v_mfma_f32_16x16x32_bf16 v[16:19], a[36:39], a[212:215], v[16:19]
    ds_read_b128 a[192:195], v14 offset:20480
    v_mfma_f32_16x16x32_bf16 v[32:35], a[40:43], a[212:215], v[32:35]
    ds_read_b128 a[196:199], v14 offset:21504
    v_fma_f32 v160, v160, v72, v64
    v_fma_f32 v161, v161, v73, v65
    v_mfma_f32_16x16x32_bf16 v[240:243], a[212:215], a[44:47], v[240:243]
    ds_read_b128 a[200:203], v14 offset:22528
    v_fma_f32 v162, v162, v74, v66
    v_mfma_f32_16x16x32_bf16 v[20:23], a[36:39], a[216:219], v[20:23]
    buffer_load_dwordx4 v8, s[44:47], s22 offen offset:1024 lds
    ds_read_b128 a[204:207], v14 offset:23552
    v_fma_f32 v163, v163, v75, v67
    v_mfma_f32_16x16x32_bf16 v[36:39], a[40:43], a[216:219], v[36:39]
    ds_read_b128 a[208:211], v14 offset:24576
    v_fma_f32 v164, v164, v76, v68
    v_fma_f32 v165, v165, v77, v69
    v_mfma_f32_16x16x32_bf16 v[244:247], a[216:219], a[44:47], v[244:247]
    v_fma_f32 v166, v166, v78, v70
    v_fma_f32 v167, v167, v79, v71
    v_mfma_f32_16x16x32_bf16 v[24:27], a[36:39], a[220:223], v[24:27]
    ds_read_b64_tr_b16 a[96:97], v9 offset:0
    v_cvt_pk_bf16_f32 v160, v160, v161
    v_mfma_f32_16x16x32_bf16 v[40:43], a[40:43], a[220:223], v[40:43]
    buffer_load_dwordx4 v8, s[44:47], s22 offen offset:2048 lds
    ds_read_b64_tr_b16 a[98:99], v9 offset:512
    v_cvt_pk_bf16_f32 v161, v162, v163
    v_cvt_pk_bf16_f32 v162, v164, v165
    v_mfma_f32_16x16x32_bf16 v[248:251], a[220:223], a[44:47], v[248:251]
    ds_read_b64_tr_b16 a[100:101], v9 offset:1024
    v_cvt_pk_bf16_f32 v163, v166, v167
    v_mfma_f32_16x16x32_bf16 v[28:31], a[36:39], a[224:227], v[28:31]
    ds_read_b64_tr_b16 a[102:103], v9 offset:1536
    v_mfma_f32_16x16x32_bf16 v[44:47], a[40:43], a[224:227], v[44:47]
    ds_write_b128 v13, v[160:163] offset:0
    s_add_u32 m0, s20, 73728
    s_add_u32 s22, s21, 688128
    buffer_load_dwordx4 v8, s[44:47], s22 offen offset:0 lds
    v_fma_f32 v168, v168, v72, v64
    v_mfma_f32_16x16x32_bf16 v[252:255], a[224:227], a[44:47], v[252:255]
    ds_read_b64_tr_b16 a[104:105], v9 offset:2048
    v_fma_f32 v169, v169, v73, v65
    v_mfma_f32_16x16x32_bf16 v[48:51], a[40:43], a[228:231], v[48:51]
    ds_read_b64_tr_b16 a[106:107], v9 offset:2560
    v_fma_f32 v170, v170, v74, v66
    v_mfma_f32_16x16x32_bf16 v[52:55], a[228:231], a[44:47], v[52:55]
    v_fma_f32 v171, v171, v75, v67
    v_fma_f32 v172, v172, v76, v68
    s_waitcnt lgkmcnt(7)
    v_mfma_f32_16x16x32_bf16 v[16:19], a[48:51], a[192:195], v[16:19]
    ds_read_b128 a[212:215], v14 offset:25600
    v_fma_f32 v173, v173, v77, v69
    v_mfma_f32_16x16x32_bf16 v[32:35], a[52:55], a[192:195], v[32:35]
    ds_read_b128 a[216:219], v14 offset:26624
    v_fma_f32 v174, v174, v78, v70
    v_mfma_f32_16x16x32_bf16 v[240:243], a[192:195], a[56:59], v[240:243]
    ds_read_b128 a[220:223], v14 offset:27648
    v_fma_f32 v175, v175, v79, v71
    v_cvt_pk_bf16_f32 v168, v168, v169
    v_mfma_f32_16x16x32_bf16 v[20:23], a[48:51], a[196:199], v[20:23]
    ds_read_b128 a[224:227], v14 offset:28672
    v_cvt_pk_bf16_f32 v169, v170, v171
    v_mfma_f32_16x16x32_bf16 v[36:39], a[52:55], a[196:199], v[36:39]
    ds_read_b128 a[228:231], v14 offset:29696
    v_cvt_pk_bf16_f32 v170, v172, v173
    v_mfma_f32_16x16x32_bf16 v[244:247], a[196:199], a[56:59], v[244:247]
    v_cvt_pk_bf16_f32 v171, v174, v175
    v_mfma_f32_16x16x32_bf16 v[24:27], a[48:51], a[200:203], v[24:27]
    ds_read_b64_tr_b16 a[108:109], v9 offset:12288
    ds_write_b128 v13, v[168:171] offset:1024
    buffer_load_dwordx4 v8, s[44:47], s22 offen offset:1024 lds
    v_mfma_f32_16x16x32_bf16 v[40:43], a[52:55], a[200:203], v[40:43]
    ds_read_b64_tr_b16 a[110:111], v9 offset:12800
    v_fma_f32 v176, v176, v72, v64
    v_mfma_f32_16x16x32_bf16 v[248:251], a[200:203], a[56:59], v[248:251]
    ds_read_b64_tr_b16 a[112:113], v9 offset:13312
    v_fma_f32 v177, v177, v73, v65
    v_fma_f32 v178, v178, v74, v66
    v_mfma_f32_16x16x32_bf16 v[28:31], a[48:51], a[204:207], v[28:31]
    ds_read_b64_tr_b16 a[114:115], v9 offset:13824
    v_fma_f32 v179, v179, v75, v67
    v_mfma_f32_16x16x32_bf16 v[44:47], a[52:55], a[204:207], v[44:47]
    v_fma_f32 v180, v180, v76, v68
    v_fma_f32 v181, v181, v77, v69
    v_mfma_f32_16x16x32_bf16 v[252:255], a[204:207], a[56:59], v[252:255]
    ds_read_b64_tr_b16 a[116:117], v9 offset:14336
    v_fma_f32 v182, v182, v78, v70
    v_fma_f32 v183, v183, v79, v71
    v_mfma_f32_16x16x32_bf16 v[48:51], a[52:55], a[208:211], v[48:51]
    ds_read_b64_tr_b16 a[118:119], v9 offset:14848
    v_cvt_pk_bf16_f32 v176, v176, v177
    v_mfma_f32_16x16x32_bf16 v[52:55], a[208:211], a[56:59], v[52:55]
    v_cvt_pk_bf16_f32 v177, v178, v179
    s_waitcnt lgkmcnt(7)
    v_mfma_f32_16x16x32_bf16 v[16:19], a[60:63], a[212:215], v[16:19]
    buffer_load_dwordx4 v8, s[44:47], s22 offen offset:2048 lds
    ds_read_b128 a[192:195], v14 offset:30720
    v_cvt_pk_bf16_f32 v178, v180, v181
    v_cvt_pk_bf16_f32 v179, v182, v183
    v_mfma_f32_16x16x32_bf16 v[32:35], a[64:67], a[212:215], v[32:35]
    ds_read_b128 a[196:199], v14 offset:31744
    v_mfma_f32_16x16x32_bf16 v[240:243], a[212:215], a[68:71], v[240:243]
    ds_read_b128 a[200:203], v14 offset:32768
    v_mfma_f32_16x16x32_bf16 v[20:23], a[60:63], a[216:219], v[20:23]
    ds_read_b128 a[204:207], v14 offset:33792
    ds_write_b128 v13, v[176:179] offset:2048
    s_add_u32 m0, s20, 86016
    s_add_u32 s22, s21, 1081344
    buffer_load_dwordx4 v8, s[44:47], s22 offen offset:0 lds
    v_fma_f32 v184, v184, v72, v64
    v_mfma_f32_16x16x32_bf16 v[36:39], a[64:67], a[216:219], v[36:39]
    ds_read_b128 a[208:211], v14 offset:34816
    v_fma_f32 v185, v185, v73, v65
    v_mfma_f32_16x16x32_bf16 v[244:247], a[216:219], a[68:71], v[244:247]
    v_fma_f32 v186, v186, v74, v66
    v_fma_f32 v187, v187, v75, v67
    v_mfma_f32_16x16x32_bf16 v[24:27], a[60:63], a[220:223], v[24:27]
    ds_read_b64_tr_b16 a[120:121], v9 offset:24576
    v_fma_f32 v188, v188, v76, v68
    v_fma_f32 v189, v189, v77, v69
    v_mfma_f32_16x16x32_bf16 v[40:43], a[64:67], a[220:223], v[40:43]
    buffer_load_dwordx4 v8, s[44:47], s22 offen offset:1024 lds
    ds_read_b64_tr_b16 a[122:123], v9 offset:25088
    v_fma_f32 v190, v190, v78, v70
    v_mfma_f32_16x16x32_bf16 v[248:251], a[220:223], a[68:71], v[248:251]
    ds_read_b64_tr_b16 a[124:125], v9 offset:25600
    v_fma_f32 v191, v191, v79, v71
    v_mfma_f32_16x16x32_bf16 v[28:31], a[60:63], a[224:227], v[28:31]
    v_cvt_pk_bf16_f32 v184, v184, v185
    v_cvt_pk_bf16_f32 v185, v186, v187
    v_cvt_pk_bf16_f32 v186, v188, v189
    v_mfma_f32_16x16x32_bf16 v[44:47], a[64:67], a[224:227], v[44:47]
    ds_read_b64_tr_b16 a[126:127], v9 offset:26112
    v_cvt_pk_bf16_f32 v187, v190, v191
    v_mfma_f32_16x16x32_bf16 v[252:255], a[224:227], a[68:71], v[252:255]
    ds_read_b64_tr_b16 a[128:129], v9 offset:26624
    v_mfma_f32_16x16x32_bf16 v[48:51], a[64:67], a[228:231], v[48:51]
    ds_read_b64_tr_b16 a[130:131], v9 offset:27136
    ds_write_b128 v13, v[184:187] offset:3072
    v_mfma_f32_16x16x32_bf16 v[52:55], a[228:231], a[68:71], v[52:55]
    v_fma_f32 v192, v192, v72, v64
    s_waitcnt lgkmcnt(7)
    v_mfma_f32_16x16x32_bf16 v[16:19], a[72:75], a[192:195], v[16:19]
    ds_read_b128 a[212:215], v14 offset:35840
    v_fma_f32 v193, v193, v73, v65
    v_mfma_f32_16x16x32_bf16 v[32:35], a[76:79], a[192:195], v[32:35]
    ds_read_b128 a[216:219], v14 offset:36864
    v_fma_f32 v194, v194, v74, v66
    v_fma_f32 v195, v195, v75, v67
    v_mfma_f32_16x16x32_bf16 v[240:243], a[192:195], a[80:83], v[240:243]
    ds_read_b128 a[220:223], v14 offset:37888
    v_fma_f32 v196, v196, v76, v68
    v_mfma_f32_16x16x32_bf16 v[20:23], a[72:75], a[196:199], v[20:23]
    ds_read_b128 a[224:227], v14 offset:38912
    v_fma_f32 v197, v197, v77, v69
    v_mfma_f32_16x16x32_bf16 v[36:39], a[76:79], a[196:199], v[36:39]
    ds_read_b128 a[228:231], v14 offset:39936
    v_fma_f32 v198, v198, v78, v70
    v_fma_f32 v199, v199, v79, v71
    v_mfma_f32_16x16x32_bf16 v[244:247], a[196:199], a[80:83], v[244:247]
    v_cvt_pk_bf16_f32 v192, v192, v193
    v_cvt_pk_bf16_f32 v193, v194, v195
    v_mfma_f32_16x16x32_bf16 v[24:27], a[72:75], a[200:203], v[24:27]
    ds_read_b64_tr_b16 a[132:133], v9 offset:36864
    v_cvt_pk_bf16_f32 v194, v196, v197
    v_mfma_f32_16x16x32_bf16 v[40:43], a[76:79], a[200:203], v[40:43]
    ds_read_b64_tr_b16 a[134:135], v9 offset:37376
    v_cvt_pk_bf16_f32 v195, v198, v199
    v_mfma_f32_16x16x32_bf16 v[248:251], a[200:203], a[80:83], v[248:251]
    ds_read_b64_tr_b16 a[136:137], v9 offset:37888
    v_mfma_f32_16x16x32_bf16 v[28:31], a[72:75], a[204:207], v[28:31]
    ds_write_b128 v13, v[192:195] offset:4096
    ds_read_b128 v[64:67], v12 offset:384
    v_mfma_f32_16x16x32_bf16 v[44:47], a[76:79], a[204:207], v[44:47]
    ds_read_b64_tr_b16 a[138:139], v9 offset:38400
    ds_read_b128 v[72:75], v12 offset:896
    ds_read_b128 v[68:71], v12 offset:400
    v_mfma_f32_16x16x32_bf16 v[252:255], a[204:207], a[80:83], v[252:255]
    buffer_load_dwordx4 v8, s[44:47], s22 offen offset:2048 lds
    ds_read_b64_tr_b16 a[140:141], v9 offset:38912
    ds_read_b128 v[76:79], v12 offset:912
    v_mfma_f32_16x16x32_bf16 v[48:51], a[76:79], a[208:211], v[48:51]
    ds_read_b64_tr_b16 a[142:143], v9 offset:39424
    v_mfma_f32_16x16x32_bf16 v[52:55], a[208:211], a[80:83], v[52:55]
    s_waitcnt lgkmcnt(0)
    s_barrier
    v_mfma_f32_16x16x32_bf16 v[16:19], a[84:87], a[212:215], v[16:19]
    ds_read_b128 a[192:195], v14 offset:0
    v_mfma_f32_16x16x32_bf16 v[32:35], a[88:91], a[212:215], v[32:35]
    ds_read_b128 a[196:199], v14 offset:1024
    v_fma_f32 v200, v200, v72, v64
    v_mfma_f32_16x16x32_bf16 v[240:243], a[212:215], a[92:95], v[240:243]
    ds_read_b128 a[200:203], v14 offset:2048
    v_mfma_f32_16x16x32_bf16 v[20:23], a[84:87], a[216:219], v[20:23]
    ds_read_b128 a[204:207], v14 offset:3072
    v_fma_f32 v201, v201, v73, v65
    v_mfma_f32_16x16x32_bf16 v[36:39], a[88:91], a[216:219], v[36:39]
    ds_read_b128 a[208:211], v14 offset:4096
    v_fma_f32 v202, v202, v74, v66
    v_mfma_f32_16x16x32_bf16 v[244:247], a[216:219], a[92:95], v[244:247]
    s_add_u32 m0, s20, 98304
    s_add_u32 s22, s21, 1474560
    buffer_load_dwordx4 v8, s[44:47], s22 offen offset:0 lds
    v_fma_f32 v203, v203, v75, v67
    v_fma_f32 v204, v204, v76, v68
    v_mfma_f32_16x16x32_bf16 v[24:27], a[84:87], a[220:223], v[24:27]
    v_fma_f32 v205, v205, v77, v69
    v_fma_f32 v206, v206, v78, v70
    v_mfma_f32_16x16x32_bf16 v[40:43], a[88:91], a[220:223], v[40:43]
    v_fma_f32 v207, v207, v79, v71
    v_cvt_pk_bf16_f32 v200, v200, v201
    v_mfma_f32_16x16x32_bf16 v[248:251], a[220:223], a[92:95], v[248:251]
    v_cvt_pk_bf16_f32 v201, v202, v203
    v_mfma_f32_16x16x32_bf16 v[28:31], a[84:87], a[224:227], v[28:31]
    buffer_load_dwordx4 v8, s[44:47], s22 offen offset:1024 lds
    v_cvt_pk_bf16_f32 v202, v204, v205
    v_cvt_pk_bf16_f32 v203, v206, v207
    v_mfma_f32_16x16x32_bf16 v[44:47], a[88:91], a[224:227], v[44:47]
    v_mfma_f32_16x16x32_bf16 v[252:255], a[224:227], a[92:95], v[252:255]
    ds_write_b128 v13, v[200:203] offset:20480
    v_fma_f32 v208, v208, v72, v64
    v_mfma_f32_16x16x32_bf16 v[48:51], a[88:91], a[228:231], v[48:51]
    buffer_load_dwordx4 v8, s[44:47], s22 offen offset:2048 lds
    v_fma_f32 v209, v209, v73, v65
    v_fma_f32 v210, v210, v74, v66
    v_mfma_f32_16x16x32_bf16 v[52:55], a[228:231], a[92:95], v[52:55]
    v_fma_f32 v211, v211, v75, v67
    s_waitcnt lgkmcnt(1)
    v_mfma_f32_16x16x32_bf16 v[16:19], a[96:99], a[192:195], v[16:19]
    ds_read_b128 a[212:215], v14 offset:5120
    v_mfma_f32_16x16x32_bf16 v[32:35], a[100:103], a[192:195], v[32:35]
    ds_read_b128 a[216:219], v14 offset:6144
    v_fma_f32 v212, v212, v76, v68
    v_mfma_f32_16x16x32_bf16 v[240:243], a[192:195], a[104:107], v[240:243]
    s_mov_b32 s22, 786432
    buffer_load_dword v10, v11, s[52:55], s22 offen
    ds_read_b128 a[220:223], v14 offset:7168
    v_fma_f32 v213, v213, v77, v69
    v_mfma_f32_16x16x32_bf16 v[20:23], a[96:99], a[196:199], v[20:23]
    ds_read_b128 a[224:227], v14 offset:8192
    v_fma_f32 v214, v214, v78, v70
    v_mfma_f32_16x16x32_bf16 v[36:39], a[100:103], a[196:199], v[36:39]
    ds_read_b128 a[228:231], v14 offset:9216
    v_fma_f32 v215, v215, v79, v71
    v_mfma_f32_16x16x32_bf16 v[244:247], a[196:199], a[104:107], v[244:247]
    v_cvt_pk_bf16_f32 v208, v208, v209
    v_cvt_pk_bf16_f32 v209, v210, v211
    v_mfma_f32_16x16x32_bf16 v[24:27], a[96:99], a[200:203], v[24:27]
    s_mov_b32 s22, 786432
    buffer_load_dword v10, v11, s[56:59], s22 offen
    v_cvt_pk_bf16_f32 v210, v212, v213
    v_mfma_f32_16x16x32_bf16 v[40:43], a[100:103], a[200:203], v[40:43]
    v_cvt_pk_bf16_f32 v211, v214, v215
    v_mfma_f32_16x16x32_bf16 v[248:251], a[200:203], a[104:107], v[248:251]
    ds_write_b128 v13, v[208:211] offset:21504
    v_mfma_f32_16x16x32_bf16 v[28:31], a[96:99], a[204:207], v[28:31]
    v_fma_f32 v216, v216, v72, v64
    v_fma_f32 v217, v217, v73, v65
    v_mfma_f32_16x16x32_bf16 v[44:47], a[100:103], a[204:207], v[44:47]
    s_add_u32 m0, s23, 110592
    s_add_u32 s22, s21, 131072
    buffer_load_dwordx4 v56, s[48:51], s22 offen lds
    v_fma_f32 v218, v218, v74, v66
    v_fma_f32 v219, v219, v75, v67
    v_mfma_f32_16x16x32_bf16 v[252:255], a[204:207], a[104:107], v[252:255]
    v_fma_f32 v220, v220, v76, v68
    v_fma_f32 v221, v221, v77, v69
    v_mfma_f32_16x16x32_bf16 v[48:51], a[100:103], a[208:211], v[48:51]
    v_fma_f32 v222, v222, v78, v70
    v_mfma_f32_16x16x32_bf16 v[52:55], a[208:211], a[104:107], v[52:55]
    v_fma_f32 v223, v223, v79, v71
    s_waitcnt lgkmcnt(1)
    v_mfma_f32_16x16x32_bf16 v[16:19], a[108:111], a[212:215], v[16:19]
    s_add_u32 m0, s23, 114688
    s_add_u32 s22, s21, 163840
    buffer_load_dwordx4 v56, s[48:51], s22 offen lds
    ds_read_b128 a[192:195], v14 offset:10240
    v_cvt_pk_bf16_f32 v216, v216, v217
    v_mfma_f32_16x16x32_bf16 v[32:35], a[112:115], a[212:215], v[32:35]
    ds_read_b128 a[196:199], v14 offset:11264
    v_cvt_pk_bf16_f32 v217, v218, v219
    v_mfma_f32_16x16x32_bf16 v[240:243], a[212:215], a[116:119], v[240:243]
    ds_read_b128 a[200:203], v14 offset:12288
    v_cvt_pk_bf16_f32 v218, v220, v221
    v_mfma_f32_16x16x32_bf16 v[20:23], a[108:111], a[216:219], v[20:23]
    ds_read_b128 a[204:207], v14 offset:13312
    v_cvt_pk_bf16_f32 v219, v222, v223
    v_mfma_f32_16x16x32_bf16 v[36:39], a[112:115], a[216:219], v[36:39]
    s_add_u32 m0, s23, 118784
    s_add_u32 s22, s21, 196608
    buffer_load_dwordx4 v56, s[48:51], s22 offen lds
    ds_read_b128 a[208:211], v14 offset:14336
    v_mfma_f32_16x16x32_bf16 v[244:247], a[216:219], a[116:119], v[244:247]
    v_mfma_f32_16x16x32_bf16 v[24:27], a[108:111], a[220:223], v[24:27]
    ds_write_b128 v13, v[216:219] offset:22528
    v_fma_f32 v224, v224, v72, v64
    v_mfma_f32_16x16x32_bf16 v[40:43], a[112:115], a[220:223], v[40:43]
    v_fma_f32 v225, v225, v73, v65
    v_fma_f32 v226, v226, v74, v66
    v_mfma_f32_16x16x32_bf16 v[248:251], a[220:223], a[116:119], v[248:251]
    s_add_u32 m0, s23, 122880
    s_add_u32 s22, s21, 229376
    buffer_load_dwordx4 v56, s[48:51], s22 offen lds
    v_fma_f32 v227, v227, v75, v67
    v_fma_f32 v228, v228, v76, v68
    v_mfma_f32_16x16x32_bf16 v[28:31], a[108:111], a[224:227], v[28:31]
    v_fma_f32 v229, v229, v77, v69
    v_fma_f32 v230, v230, v78, v70
    v_mfma_f32_16x16x32_bf16 v[44:47], a[112:115], a[224:227], v[44:47]
    v_fma_f32 v231, v231, v79, v71
    v_mfma_f32_16x16x32_bf16 v[252:255], a[224:227], a[116:119], v[252:255]
    v_cvt_pk_bf16_f32 v224, v224, v225
    v_cvt_pk_bf16_f32 v225, v226, v227
    v_mfma_f32_16x16x32_bf16 v[48:51], a[112:115], a[228:231], v[48:51]
    s_add_u32 m0, s23, 126976
    s_add_u32 s22, s21, 262144
    buffer_load_dwordx4 v56, s[48:51], s22 offen lds
    v_cvt_pk_bf16_f32 v226, v228, v229
    v_cvt_pk_bf16_f32 v227, v230, v231
    v_mfma_f32_16x16x32_bf16 v[52:55], a[228:231], a[116:119], v[52:55]
    s_waitcnt lgkmcnt(1)
    v_mfma_f32_16x16x32_bf16 v[16:19], a[120:123], a[192:195], v[16:19]
    ds_read_b128 a[212:215], v14 offset:15360
    v_mfma_f32_16x16x32_bf16 v[32:35], a[124:127], a[192:195], v[32:35]
    ds_read_b128 a[216:219], v14 offset:16384
    ds_write_b128 v13, v[224:227] offset:23552
    v_mfma_f32_16x16x32_bf16 v[240:243], a[192:195], a[128:131], v[240:243]
    ds_read_b128 a[220:223], v14 offset:17408
    v_mfma_f32_16x16x32_bf16 v[20:23], a[120:123], a[196:199], v[20:23]
    ds_read_b128 a[224:227], v14 offset:18432
    v_fma_f32 v232, v232, v72, v64
    v_mfma_f32_16x16x32_bf16 v[36:39], a[124:127], a[196:199], v[36:39]
    s_add_u32 m0, s23, 131072
    s_add_u32 s22, s21, 294912
    buffer_load_dwordx4 v56, s[48:51], s22 offen lds
    ds_read_b128 a[228:231], v14 offset:19456
    v_fma_f32 v233, v233, v73, v65
    v_mfma_f32_16x16x32_bf16 v[244:247], a[196:199], a[128:131], v[244:247]
    v_fma_f32 v234, v234, v74, v66
    v_fma_f32 v235, v235, v75, v67
    v_mfma_f32_16x16x32_bf16 v[24:27], a[120:123], a[200:203], v[24:27]
    v_fma_f32 v236, v236, v76, v68
    v_fma_f32 v237, v237, v77, v69
    v_mfma_f32_16x16x32_bf16 v[40:43], a[124:127], a[200:203], v[40:43]
    v_fma_f32 v238, v238, v78, v70
    v_fma_f32 v239, v239, v79, v71
    v_mfma_f32_16x16x32_bf16 v[248:251], a[200:203], a[128:131], v[248:251]
    v_cvt_pk_bf16_f32 v232, v232, v233
    v_mfma_f32_16x16x32_bf16 v[28:31], a[120:123], a[204:207], v[28:31]
    v_cvt_pk_bf16_f32 v233, v234, v235
    v_cvt_pk_bf16_f32 v234, v236, v237
    v_mfma_f32_16x16x32_bf16 v[44:47], a[124:127], a[204:207], v[44:47]
    v_cvt_pk_bf16_f32 v235, v238, v239
    v_mfma_f32_16x16x32_bf16 v[252:255], a[204:207], a[128:131], v[252:255]
    ds_write_b128 v13, v[232:235] offset:24576
    s_add_u32 m0, s23, 135168
    s_add_u32 s22, s21, 327680
    buffer_load_dwordx4 v56, s[48:51], s22 offen lds
    v_mfma_f32_16x16x32_bf16 v[48:51], a[124:127], a[208:211], v[48:51]
    v_mfma_f32_16x16x32_bf16 v[52:55], a[208:211], a[128:131], v[52:55]
    s_add_u32 m0, s23, 139264
    s_add_u32 s22, s21, 360448
    buffer_load_dwordx4 v56, s[48:51], s22 offen lds
    s_add_u32 m0, s23, 143360
    s_add_u32 s22, s21, 393216
    buffer_load_dwordx4 v56, s[48:51], s22 offen lds
    s_waitcnt vmcnt(11)
    s_waitcnt lgkmcnt(0)
    s_barrier
    v_add_u32 v9, 4294918144, v9
    v_mfma_f32_16x16x32_bf16 v[16:19], a[132:135], a[212:215], v[16:19]
    ds_read_b128 a[192:195], v14 offset:20480
    ds_read_b64_tr_b16 a[144:145], v9 offset:0
    v_mfma_f32_16x16x32_bf16 v[32:35], a[136:139], a[212:215], v[32:35]
    ds_read_b128 a[196:199], v14 offset:21504
    ds_read_b64_tr_b16 a[146:147], v9 offset:512
    v_lshlrev_b32 v208, 16, v112
    v_and_b32 v209, s86, v112
    v_mfma_f32_16x16x32_bf16 v[240:243], a[212:215], a[140:143], v[240:243]
    ds_read_b128 a[200:203], v14 offset:22528
    ds_read_b64_tr_b16 a[148:149], v9 offset:1024
    v_lshlrev_b32_e64 v210, 16, v113
    v_mfma_f32_16x16x32_bf16 v[20:23], a[132:135], a[216:219], v[20:23]
    ds_read_b128 a[204:207], v14 offset:23552
    ds_read_b64_tr_b16 a[150:151], v9 offset:1536
    v_and_b32_e64 v211, s86, v113
    v_mul_f32 v212, 0xbfb8aa3b, v208
    v_mfma_f32_16x16x32_bf16 v[36:39], a[136:139], a[216:219], v[36:39]
    ds_read_b128 a[208:211], v14 offset:24576
    ds_read_b64_tr_b16 a[152:153], v9 offset:2048
    v_mul_f32 v213, 0xbfb8aa3b, v209
    v_mfma_f32_16x16x32_bf16 v[244:247], a[216:219], a[140:143], v[244:247]
    ds_read_b64_tr_b16 a[154:155], v9 offset:2560
    v_mul_f32 v214, 0xbfb8aa3b, v210
    v_mul_f32 v215, 0xbfb8aa3b, v211
    v_mfma_f32_16x16x32_bf16 v[24:27], a[132:135], a[220:223], v[24:27]
    ds_read_b64_tr_b16 a[156:157], v9 offset:12288
    v_exp_f32_e64 v212, v212
    v_mfma_f32_16x16x32_bf16 v[40:43], a[136:139], a[220:223], v[40:43]
    ds_read_b64_tr_b16 a[158:159], v9 offset:12800
    v_exp_f32 v213, v213
    v_exp_f32 v214, v214
    v_mfma_f32_16x16x32_bf16 v[248:251], a[220:223], a[140:143], v[248:251]
    ds_read_b64_tr_b16 a[160:161], v9 offset:13312
    v_exp_f32_e64 v215, v215
    v_mfma_f32_16x16x32_bf16 v[28:31], a[132:135], a[224:227], v[28:31]
    ds_read_b64_tr_b16 a[162:163], v9 offset:13824
    v_add_f32 v212, 1.0, v212
    v_add_f32 v213, 1.0, v213
    v_add_f32_e64 v214, 1.0, v214
    v_mfma_f32_16x16x32_bf16 v[44:47], a[136:139], a[224:227], v[44:47]
    ds_read_b64_tr_b16 a[164:165], v9 offset:14336
    v_add_f32_e64 v215, 1.0, v215
    v_mfma_f32_16x16x32_bf16 v[252:255], a[224:227], a[140:143], v[252:255]
    ds_read_b64_tr_b16 a[166:167], v9 offset:14848
    v_rcp_f32 v212, v212
    v_rcp_f32 v213, v213
    v_mfma_f32_16x16x32_bf16 v[48:51], a[136:139], a[228:231], v[48:51]
    ds_read_b64_tr_b16 a[168:169], v9 offset:24576
    v_rcp_f32_e64 v214, v214
    v_mfma_f32_16x16x32_bf16 v[52:55], a[228:231], a[140:143], v[52:55]
    ds_read_b64_tr_b16 a[170:171], v9 offset:25088
    s_waitcnt lgkmcnt(8)
    v_mfma_f32_16x16x32_bf16 v[16:19], a[144:147], a[192:195], v[16:19]
    ds_read_b128 a[212:215], v14 offset:25600
    ds_read_b64_tr_b16 a[172:173], v9 offset:25600
    v_rcp_f32 v215, v215
    v_mul_f32_e64 v208, v208, v212
    v_mfma_f32_16x16x32_bf16 v[32:35], a[148:151], a[192:195], v[32:35]
    ds_read_b128 a[216:219], v14 offset:26624
    ds_read_b64_tr_b16 a[174:175], v9 offset:26112
    v_mul_f32_e64 v209, v209, v213
    v_mfma_f32_16x16x32_bf16 v[240:243], a[192:195], a[152:155], v[240:243]
    ds_read_b128 a[220:223], v14 offset:27648
    ds_read_b64_tr_b16 a[176:177], v9 offset:26624
    v_mul_f32 v210, v210, v214
    v_mul_f32 v211, v211, v215
    v_mfma_f32_16x16x32_bf16 v[20:23], a[144:147], a[196:199], v[20:23]
    ds_read_b128 a[224:227], v14 offset:28672
    ds_read_b64_tr_b16 a[178:179], v9 offset:27136
    v_cvt_pk_bf16_f32 v200, 0, v208
    v_mfma_f32_16x16x32_bf16 v[36:39], a[148:151], a[196:199], v[36:39]
    ds_read_b128 a[228:231], v14 offset:29696
    ds_read_b64_tr_b16 a[180:181], v9 offset:36864
    v_cvt_pk_bf16_f32 v201, 0, v209
    v_cvt_pk_bf16_f32 v202, 0, v210
    v_mfma_f32_16x16x32_bf16 v[244:247], a[196:199], a[152:155], v[244:247]
    ds_read_b64_tr_b16 a[182:183], v9 offset:37376
    v_cvt_pk_bf16_f32 v203, 0, v211
    v_lshlrev_b32_e64 v204, 16, v96
    v_mfma_f32_16x16x32_bf16 v[24:27], a[144:147], a[200:203], v[24:27]
    ds_read_b64_tr_b16 a[184:185], v9 offset:37888
    v_and_b32 v205, s86, v96
    v_mul_f32 v208, v204, v200
    v_mul_f32_e64 v209, v205, v200
    v_mfma_f32_16x16x32_bf16 v[40:43], a[148:151], a[200:203], v[40:43]
    ds_read_b64_tr_b16 a[186:187], v9 offset:38400
    v_lshlrev_b32 v204, 16, v97
    v_and_b32 v205, s86, v97
    v_mfma_f32_16x16x32_bf16 v[248:251], a[200:203], a[152:155], v[248:251]
    ds_read_b64_tr_b16 a[188:189], v9 offset:38912
    v_mul_f32 v210, v204, v200
    v_mul_f32 v211, v205, v200
    v_lshlrev_b32_e64 v204, 16, v98
    v_mfma_f32_16x16x32_bf16 v[28:31], a[144:147], a[204:207], v[28:31]
    ds_read_b64_tr_b16 a[190:191], v9 offset:39424
    v_and_b32 v205, s86, v98
    v_mul_f32 v212, v204, v200
    v_mfma_f32_16x16x32_bf16 v[44:47], a[148:151], a[204:207], v[44:47]
    v_mul_f32 v213, v205, v200
    v_lshlrev_b32 v204, 16, v99
    v_and_b32 v205, s86, v99
    v_mul_f32 v214, v204, v200
    v_mfma_f32_16x16x32_bf16 v[252:255], a[204:207], a[152:155], v[252:255]
    v_mul_f32 v215, v205, v200
    v_lshlrev_b32 v204, 16, v100
    v_and_b32_e64 v205, s86, v100
    v_mfma_f32_16x16x32_bf16 v[48:51], a[148:151], a[208:211], v[48:51]
    v_fma_f32 v208, v204, v201, v208
    v_fma_f32 v209, v205, v201, v209
    v_lshlrev_b32_e64 v204, 16, v101
    v_mfma_f32_16x16x32_bf16 v[52:55], a[208:211], a[152:155], v[52:55]
    v_and_b32_e64 v205, s86, v101
    v_fma_f32 v210, v204, v201, v210
    v_fma_f32 v211, v205, v201, v211
    s_waitcnt lgkmcnt(6)
    v_mfma_f32_16x16x32_bf16 v[16:19], a[156:159], a[212:215], v[16:19]
    ds_read_b128 a[192:195], v14 offset:30720
    v_lshlrev_b32 v204, 16, v102
    v_and_b32_e64 v205, s86, v102
    v_mfma_f32_16x16x32_bf16 v[32:35], a[160:163], a[212:215], v[32:35]
    ds_read_b128 a[196:199], v14 offset:31744
    v_fma_f32 v212, v204, v201, v212
    v_fma_f32 v213, v205, v201, v213
    v_lshlrev_b32_e64 v204, 16, v103
    v_mfma_f32_16x16x32_bf16 v[240:243], a[212:215], a[164:167], v[240:243]
    ds_read_b128 a[200:203], v14 offset:32768
    v_and_b32_e64 v205, s86, v103
    v_fma_f32 v214, v204, v201, v214
    v_mfma_f32_16x16x32_bf16 v[20:23], a[156:159], a[216:219], v[20:23]
    ds_read_b128 a[204:207], v14 offset:33792
    v_fma_f32 v215, v205, v201, v215
    v_lshlrev_b32 v204, 16, v104
    v_and_b32 v205, s86, v104
    v_mfma_f32_16x16x32_bf16 v[36:39], a[160:163], a[216:219], v[36:39]
    ds_read_b128 a[208:211], v14 offset:34816
    v_fma_f32 v208, v204, v202, v208
    v_fma_f32 v209, v205, v202, v209
    v_mfma_f32_16x16x32_bf16 v[244:247], a[216:219], a[164:167], v[244:247]
    v_lshlrev_b32 v204, 16, v105
    v_and_b32 v205, s86, v105
    v_fma_f32 v210, v204, v202, v210
    v_fma_f32 v211, v205, v202, v211
    v_mfma_f32_16x16x32_bf16 v[24:27], a[156:159], a[220:223], v[24:27]
    v_lshlrev_b32 v204, 16, v106
    v_and_b32 v205, s86, v106
    v_fma_f32 v212, v204, v202, v212
    v_mfma_f32_16x16x32_bf16 v[40:43], a[160:163], a[220:223], v[40:43]
    s_add_u32 m0, s23, 147456
    s_add_u32 s22, s21, 425984
    buffer_load_dwordx4 v56, s[48:51], s22 offen lds
    v_fma_f32 v213, v205, v202, v213
    v_lshlrev_b32 v204, 16, v107
    v_and_b32 v205, s86, v107
    v_fma_f32 v214, v204, v202, v214
    v_mfma_f32_16x16x32_bf16 v[248:251], a[220:223], a[164:167], v[248:251]
    v_fma_f32 v215, v205, v202, v215
    v_lshlrev_b32 v204, 16, v108
    v_and_b32 v205, s86, v108
    v_mfma_f32_16x16x32_bf16 v[28:31], a[156:159], a[224:227], v[28:31]
    v_fma_f32 v208, v204, v203, v208
    v_fma_f32 v209, v205, v203, v209
    v_lshlrev_b32 v204, 16, v109
    v_and_b32 v205, s86, v109
    v_mfma_f32_16x16x32_bf16 v[44:47], a[160:163], a[224:227], v[44:47]
    s_add_u32 m0, s23, 151552
    s_add_u32 s22, s21, 458752
    buffer_load_dwordx4 v56, s[48:51], s22 offen lds
    v_fma_f32 v210, v204, v203, v210
    v_fma_f32 v211, v205, v203, v211
    v_lshlrev_b32_e64 v204, 16, v110
    v_mfma_f32_16x16x32_bf16 v[252:255], a[224:227], a[164:167], v[252:255]
    v_and_b32_e64 v205, s86, v110
    v_fma_f32 v212, v204, v203, v212
    v_fma_f32 v213, v205, v203, v213
    v_lshlrev_b32_e64 v204, 16, v111
    v_mfma_f32_16x16x32_bf16 v[48:51], a[160:163], a[228:231], v[48:51]
    v_and_b32_e64 v205, s86, v111
    v_fma_f32 v214, v204, v203, v214
    v_fma_f32 v215, v205, v203, v215
    v_mfma_f32_16x16x32_bf16 v[52:55], a[228:231], a[164:167], v[52:55]
    s_add_u32 m0, s23, 155648
    s_add_u32 s22, s21, 491520
    buffer_load_dwordx4 v56, s[48:51], s22 offen lds
    v_and_b32 v216, 7, v0
    v_lshlrev_b32_e64 v216, 5, v216
    s_waitcnt lgkmcnt(0)
    v_mfma_f32_16x16x32_bf16 v[16:19], a[168:171], a[192:195], v[16:19]
    ds_read_b128 a[212:215], v14 offset:35840
    v_and_b32_e64 v217, 1, v2
    v_lshl_add_u32 v216, v217, 3, v216
    v_permlane32_swap_b32 v208, v209
    v_mfma_f32_16x16x32_bf16 v[32:35], a[172:175], a[192:195], v[32:35]
    ds_read_b128 a[216:219], v14 offset:36864
    v_permlane32_swap_b32 v210, v211
    v_permlane32_swap_b32 v212, v213
    v_mfma_f32_16x16x32_bf16 v[240:243], a[192:195], a[176:179], v[240:243]
    s_mov_b32 s22, 0
    buffer_load_dword v10, v11, s[60:63], s22 offen
    ds_read_b128 a[220:223], v14 offset:37888
    v_permlane32_swap_b32 v214, v215
    v_add_f32 v208, v208, v209
    v_add_f32_e64 v210, v210, v211
    v_mfma_f32_16x16x32_bf16 v[20:23], a[168:171], a[196:199], v[20:23]
    ds_read_b128 a[224:227], v14 offset:38912
    v_add_f32 v212, v212, v213
    v_add_f32 v214, v214, v215
    v_mfma_f32_16x16x32_bf16 v[36:39], a[172:175], a[196:199], v[36:39]
    ds_read_b128 a[228:231], v14 offset:39936
    v_lshrrev_b32_e64 v217, 1, v2
    v_lshl_add_u32 v216, v217, 2, v216
    v_permlane16_swap_b32 v208, v210
    v_mfma_f32_16x16x32_bf16 v[244:247], a[196:199], a[176:179], v[244:247]
    s_mov_b32 s22, 786432
    buffer_load_dword v10, v11, s[60:63], s22 offen
    v_permlane16_swap_b32 v212, v214
    v_add_f32 v208, v208, v210
    v_add_f32 v212, v212, v214
    v_mfma_f32_16x16x32_bf16 v[24:27], a[168:171], a[200:203], v[24:27]
    s_lshl_b32 s28, s4, 8
    v_add_u32 v216, s28, v216
    v_add_f32_dpp v209, v208, v208 row_ror:8 row_mask:0xf bank_mask:0xf
    v_add_f32_dpp v213, v212, v212 row_ror:8 row_mask:0xf bank_mask:0xf
    v_mfma_f32_16x16x32_bf16 v[40:43], a[172:175], a[200:203], v[40:43]
    ds_write_b32 v216, v209 offset:2560
    ds_write_b32 v216, v213 offset:2576
    v_add_u32 v4, 159744, v1
    v_mfma_f32_16x16x32_bf16 v[248:251], a[200:203], a[176:179], v[248:251]
    ds_read_b128 v[168:171], v4 offset:0
    ds_read_b128 v[172:175], v4 offset:1024
    ds_read_b128 v[176:179], v4 offset:2048
    ds_read_b128 v[180:183], v4 offset:3072
    buffer_load_dwordx4 v[88:91], v61, s[40:43], s88 offen offset:0
    v_mfma_f32_16x16x32_bf16 v[28:31], a[168:171], a[204:207], v[28:31]
    ds_read_b128 v[84:87], v1 offset:10240
    v_accvgpr_read_b32 v80, a250
    v_accvgpr_read_b32 v81, a251
    v_mfma_f32_16x16x32_bf16 v[44:47], a[172:175], a[204:207], v[44:47]
    v_accvgpr_read_b32 v82, a252
    v_accvgpr_read_b32 v83, a253
    v_mov_b32 v184, s85
    v_mov_b32 v185, s85
    v_mfma_f32_16x16x32_bf16 v[252:255], a[204:207], a[176:179], v[252:255]
    v_mov_b32 v186, s85
    v_mov_b32 v187, s85
    v_lshlrev_b32_e64 v76, 2, v0
    v_mfma_f32_16x16x32_bf16 v[48:51], a[172:175], a[208:211], v[48:51]
    v_mfma_f32_16x16x32_bf16 v[52:55], a[208:211], a[176:179], v[52:55]
    s_waitcnt lgkmcnt(0)
    s_barrier
    v_mfma_f32_16x16x32_bf16 v[16:19], a[180:183], a[212:215], v[16:19]
    s_add_u32 m0, s23, 94208
    s_add_u32 s22, s21, 0
    buffer_load_dwordx4 v56, s[48:51], s22 offen lds
    v_mfma_f32_16x16x32_bf16 v[32:35], a[184:187], a[212:215], v[32:35]
    v_mfma_f32_16x16x32_bf16 v[240:243], a[212:215], a[188:191], v[240:243]
    v_mfma_f32_16x16x32_bf16 v[20:23], a[180:183], a[216:219], v[20:23]
    v_mfma_f32_16x16x32_bf16 v[36:39], a[184:187], a[216:219], v[36:39]
    s_add_u32 m0, s23, 98304
    s_add_u32 s22, s21, 32768
    buffer_load_dwordx4 v56, s[48:51], s22 offen lds
    v_mfma_f32_16x16x32_bf16 v[244:247], a[216:219], a[188:191], v[244:247]
    v_mfma_f32_16x16x32_bf16 v[24:27], a[180:183], a[220:223], v[24:27]
    v_mfma_f32_16x16x32_bf16 v[40:43], a[184:187], a[220:223], v[40:43]
    v_mfma_f32_16x16x32_bf16 v[248:251], a[220:223], a[188:191], v[248:251]
    s_add_u32 m0, s23, 102400
    s_add_u32 s22, s21, 65536
    buffer_load_dwordx4 v56, s[48:51], s22 offen lds
    v_mfma_f32_16x16x32_bf16 v[28:31], a[180:183], a[224:227], v[28:31]
    v_mfma_f32_16x16x32_bf16 v[44:47], a[184:187], a[224:227], v[44:47]
    v_mfma_f32_16x16x32_bf16 v[252:255], a[224:227], a[188:191], v[252:255]
    v_mfma_f32_16x16x32_bf16 v[48:51], a[184:187], a[228:231], v[48:51]
    s_add_u32 m0, s23, 106496
    s_add_u32 s22, s21, 98304
    buffer_load_dwordx4 v56, s[48:51], s22 offen lds
    v_mfma_f32_16x16x32_bf16 v[52:55], a[228:231], a[188:191], v[52:55]
    s_sub_u32 s12, s10, 1
    s_cmp_lt_u32 s12, 2
    s_cbranch_scc0 L_nomod_9
    s_cmp_lg_u32 s4, 3
    s_cbranch_scc1 L_nomod_9
    v_lshlrev_b32_e64 v4, 4, v3
    ds_read_b128 v[96:99], v4 offset:2560
    ds_read_b128 v[100:103], v4 offset:2816
    ds_read_b128 v[104:107], v4 offset:3072
    ds_read_b128 v[108:111], v4 offset:3328
    s_and_b32 s13, s8, 0xff
    s_mov_b32 s14, 0xffffff00
    v_mov_b32 v5, s13
    s_and_b32 s12, s3, 3
    s_mul_i32 s12, s12, 12288
    s_lshr_b32 s13, s3, 2
    s_lshl_b32 s13, s13, 8
    s_add_u32 s12, s12, s13
    s_add_u32 s12, s12, 917504
    s_waitcnt lgkmcnt(0)
    v_pk_add_f32 v[96:97], v[96:97], v[100:101]
    v_pk_add_f32 v[104:105], v[104:105], v[108:109]
    v_pk_add_f32 v[98:99], v[98:99], v[102:103]
    v_pk_add_f32 v[106:107], v[106:107], v[110:111]
    v_pk_add_f32 v[96:97], v[96:97], v[104:105]
    v_pk_add_f32 v[98:99], v[98:99], v[106:107]
    v_and_or_b32 v96, v96, s14, v5
    v_and_or_b32 v97, v97, s14, v5
    v_and_or_b32 v98, v98, s14, v5
    v_and_or_b32 v99, v99, s14, v5
    s_mov_b64 exec, 0xffff
    buffer_store_dwordx4 v[96:99], v4, s[72:75], s12 offen sc1
    s_mov_b64 exec, -1
    s_nop 0
L_nomod_9:
    v_cvt_pk_bf16_f32 v140, v16, v17
    v_cvt_pk_bf16_f32 v148, v32, v33
    v_cvt_pk_bf16_f32 v141, v18, v19
    v_cvt_pk_bf16_f32 v149, v34, v35
    v_cvt_pk_bf16_f32 v142, v20, v21
    v_cvt_pk_bf16_f32 v150, v36, v37
    v_cvt_pk_bf16_f32 v143, v22, v23
    v_cvt_pk_bf16_f32 v151, v38, v39
    v_cvt_pk_bf16_f32 v144, v24, v25
    v_cvt_pk_bf16_f32 v152, v40, v41
    v_cvt_pk_bf16_f32 v145, v26, v27
    v_cvt_pk_bf16_f32 v153, v42, v43
    v_cvt_pk_bf16_f32 v146, v28, v29
    v_cvt_pk_bf16_f32 v154, v44, v45
    v_cvt_pk_bf16_f32 v147, v30, v31
    v_cvt_pk_bf16_f32 v155, v46, v47
    v_cvt_pk_bf16_f32 v156, v48, v49
    v_cvt_pk_bf16_f32 v157, v50, v51
    v_cvt_pk_bf16_f32 v160, v240, v241
    v_cvt_pk_bf16_f32 v161, v242, v243
    v_mfma_f32_16x16x16_bf16 v[204:207], v[152:153], v[144:145], v[168:171]
    v_cvt_pk_bf16_f32 v164, v244, v245
    v_mfma_f32_16x16x16_bf16 v[208:211], v[148:149], v[144:145], v[172:175]
    v_cvt_pk_bf16_f32 v165, v246, v247
    v_mfma_f32_16x16x16_bf16 v[212:215], v[154:155], v[146:147], v[168:171]
    v_cvt_pk_bf16_f32 v158, v248, v249
    v_mfma_f32_16x16x16_bf16 v[216:219], v[150:151], v[146:147], v[172:175]
    v_cvt_pk_bf16_f32 v159, v250, v251
    v_mfma_f32_16x16x16_bf16 v[188:191], v[148:149], v[140:141], v[168:171]
    v_cvt_pk_bf16_f32 v166, v252, v253
    v_mfma_f32_16x16x16_bf16 v[192:195], v[156:157], v[140:141], v[176:179]
    v_cvt_pk_bf16_f32 v167, v254, v255
    v_mfma_f32_16x16x16_bf16 v[196:199], v[150:151], v[142:143], v[168:171]
    v_cvt_pk_bf16_f32 v162, v52, v53
    v_mfma_f32_16x16x16_bf16 v[200:203], v[156:157], v[142:143], v[180:183]
    v_cvt_pk_bf16_f32 v163, v54, v55
    s_mov_b32 s12, 0x3eb8aa3b
    s_mov_b32 s13, 0xbeb8aa3b
    v_max3_f32 v222, v204, v205, v206
    v_max3_f32 v226, v207, v208, v209
    v_max3_f32 v222, v222, v210, v211
    v_max_f32 v222, v222, v226
    v_mov_b32 v226, v222
    v_max3_f32 v223, v212, v213, v214
    v_max3_f32 v227, v215, v216, v217
    v_max3_f32 v223, v223, v218, v219
    v_max_f32 v223, v223, v227
    v_mov_b32 v227, v223
    v_max3_f32 v220, v188, v189, v190
    v_max3_f32 v224, v191, v192, v193
    v_max3_f32 v220, v220, v194, v195
    v_max_f32 v220, v220, v224
    v_mov_b32 v224, v220
    v_max3_f32 v221, v196, v197, v198
    v_max3_f32 v225, v199, v200, v201
    v_max3_f32 v221, v221, v202, v203
    v_max_f32 v221, v221, v225
    v_mov_b32 v225, v221
    v_permlane32_swap_b32 v222, v226
    v_permlane32_swap_b32 v223, v227
    v_permlane32_swap_b32 v220, v224
    v_permlane32_swap_b32 v221, v225
    v_max_f32 v222, v222, v226
    v_max_f32 v223, v223, v227
    v_max_f32 v220, v220, v224
    v_max_f32 v221, v221, v225
    v_mov_b32 v226, v222
    v_mov_b32 v227, v223
    v_mov_b32 v224, v220
    v_mov_b32 v225, v221
    buffer_load_dwordx4 v[92:95], v61, s[40:43], s88 offen offset:64
    buffer_load_dword v77, v76, s[72:75], s84 offen sc1
    v_permlane16_swap_b32 v222, v226
    v_permlane16_swap_b32 v223, v227
    v_permlane16_swap_b32 v220, v224
    v_permlane16_swap_b32 v221, v225
    v_max_f32 v222, v222, v226
    v_max_f32 v223, v223, v227
    v_max_f32 v220, v220, v224
    v_max_f32 v221, v221, v225
    v_mul_f32 v224, s13, v220
    v_mul_f32 v225, s13, v221
    v_mul_f32 v226, s13, v222
    v_mul_f32 v227, s13, v223
    v_pk_fma_f32 v[188:189], v[188:189], s[12:13], v[224:225] op_sel:[0,0,0] op_sel_hi:[1,0,0]
    v_pk_fma_f32 v[190:191], v[190:191], s[12:13], v[224:225] op_sel:[0,0,0] op_sel_hi:[1,0,0]
    v_pk_fma_f32 v[192:193], v[192:193], s[12:13], v[224:225] op_sel:[0,0,0] op_sel_hi:[1,0,0]
    v_pk_fma_f32 v[194:195], v[194:195], s[12:13], v[224:225] op_sel:[0,0,0] op_sel_hi:[1,0,0]
    v_pk_fma_f32 v[196:197], v[196:197], s[12:13], v[224:225] op_sel:[0,0,1] op_sel_hi:[1,0,1]
    v_pk_fma_f32 v[198:199], v[198:199], s[12:13], v[224:225] op_sel:[0,0,1] op_sel_hi:[1,0,1]
    v_pk_fma_f32 v[200:201], v[200:201], s[12:13], v[224:225] op_sel:[0,0,1] op_sel_hi:[1,0,1]
    v_pk_fma_f32 v[202:203], v[202:203], s[12:13], v[224:225] op_sel:[0,0,1] op_sel_hi:[1,0,1]
    v_pk_fma_f32 v[204:205], v[204:205], s[12:13], v[226:227] op_sel:[0,0,0] op_sel_hi:[1,0,0]
    v_pk_fma_f32 v[206:207], v[206:207], s[12:13], v[226:227] op_sel:[0,0,0] op_sel_hi:[1,0,0]
    v_pk_fma_f32 v[208:209], v[208:209], s[12:13], v[226:227] op_sel:[0,0,0] op_sel_hi:[1,0,0]
    v_pk_fma_f32 v[210:211], v[210:211], s[12:13], v[226:227] op_sel:[0,0,0] op_sel_hi:[1,0,0]
    v_pk_fma_f32 v[212:213], v[212:213], s[12:13], v[226:227] op_sel:[0,0,1] op_sel_hi:[1,0,1]
    v_pk_fma_f32 v[214:215], v[214:215], s[12:13], v[226:227] op_sel:[0,0,1] op_sel_hi:[1,0,1]
    v_pk_fma_f32 v[216:217], v[216:217], s[12:13], v[226:227] op_sel:[0,0,1] op_sel_hi:[1,0,1]
    v_pk_fma_f32 v[218:219], v[218:219], s[12:13], v[226:227] op_sel:[0,0,1] op_sel_hi:[1,0,1]
    v_exp_f32 v188, v188
    v_exp_f32 v189, v189
    v_exp_f32 v190, v190
    v_exp_f32 v191, v191
    v_exp_f32 v192, v192
    v_exp_f32 v193, v193
    v_exp_f32 v194, v194
    v_exp_f32 v195, v195
    v_cvt_pk_bf16_f32 v16, v188, v189
    v_cvt_pk_bf16_f32 v18, v192, v193
    v_cvt_pk_bf16_f32 v17, v190, v191
    v_cvt_pk_bf16_f32 v19, v194, v195
    s_nop 1
    v_mfma_f32_16x16x32_bf16 v[228:231], v[184:187], v[16:19], 0
    v_mfma_f32_16x16x32_bf16 v[32:35], v[160:163], v[16:19], 0
    v_exp_f32 v196, v196
    v_exp_f32 v197, v197
    v_exp_f32 v198, v198
    v_exp_f32 v199, v199
    v_exp_f32 v200, v200
    v_exp_f32 v201, v201
    v_exp_f32 v202, v202
    v_exp_f32 v203, v203
    v_rcp_f32 v228, v228
    v_cvt_pk_bf16_f32 v22, v196, v197
    v_cvt_pk_bf16_f32 v20, v200, v201
    v_cvt_pk_bf16_f32 v23, v198, v199
    v_cvt_pk_bf16_f32 v21, v202, v203
    v_pk_mul_f32 v[32:33], v[32:33], v[228:229] op_sel_hi:[1,0]
    v_pk_mul_f32 v[34:35], v[34:35], v[228:229] op_sel_hi:[1,0]
    v_cvt_pk_bf16_f32 v48, v32, v33
    v_cvt_pk_bf16_f32 v49, v34, v35
    v_mfma_f32_16x16x32_bf16 v[232:235], v[184:187], v[20:23], 0
    v_mfma_f32_16x16x32_bf16 v[36:39], v[162:165], v[20:23], 0
    v_exp_f32 v204, v204
    v_exp_f32 v205, v205
    v_exp_f32 v206, v206
    v_exp_f32 v207, v207
    v_exp_f32 v208, v208
    v_exp_f32 v209, v209
    v_exp_f32 v210, v210
    v_exp_f32 v211, v211
    v_rcp_f32_e64 v232, v232
    v_cvt_pk_bf16_f32 v24, v204, v205
    v_cvt_pk_bf16_f32 v26, v208, v209
    v_cvt_pk_bf16_f32 v25, v206, v207
    v_cvt_pk_bf16_f32 v27, v210, v211
    v_pk_mul_f32 v[36:37], v[36:37], v[232:233] op_sel_hi:[1,0]
    v_pk_mul_f32 v[38:39], v[38:39], v[232:233] op_sel_hi:[1,0]
    v_cvt_pk_bf16_f32 v50, v36, v37
    v_cvt_pk_bf16_f32 v51, v38, v39
    v_mfma_f32_16x16x32_bf16 v[236:239], v[184:187], v[24:27], 0
    v_mfma_f32_16x16x32_bf16 v[40:43], v[158:161], v[24:27], 0
    v_exp_f32 v212, v212
    v_exp_f32 v213, v213
    v_exp_f32 v214, v214
    v_exp_f32 v215, v215
    v_exp_f32 v216, v216
    v_exp_f32 v217, v217
    v_exp_f32 v218, v218
    v_exp_f32 v219, v219
    v_rcp_f32_e64 v236, v236
    v_cvt_pk_bf16_f32 v30, v212, v213
    v_cvt_pk_bf16_f32 v28, v216, v217
    v_cvt_pk_bf16_f32 v31, v214, v215
    v_cvt_pk_bf16_f32 v29, v218, v219
    v_pk_mul_f32 v[40:41], v[40:41], v[236:237] op_sel_hi:[1,0]
    v_pk_mul_f32 v[42:43], v[42:43], v[236:237] op_sel_hi:[1,0]
    v_cvt_pk_bf16_f32 v52, v40, v41
    v_cvt_pk_bf16_f32 v53, v42, v43
    v_mfma_f32_16x16x32_bf16 v[240:243], v[184:187], v[28:31], 0
    v_mfma_f32_16x16x32_bf16 v[44:47], v[164:167], v[28:31], 0
    v_permlane16_swap_b32 v48, v50
    v_permlane16_swap_b32 v49, v51
    s_add_u32 s16, s96, 32768
    buffer_store_dwordx4 v[48:51], v60, s[72:75], s96 offen sc1
    s_nop 2
    v_rcp_f32_e64 v240, v240
    s_nop 0
    v_pk_mul_f32 v[44:45], v[44:45], v[240:241] op_sel_hi:[1,0]
    v_pk_mul_f32 v[46:47], v[46:47], v[240:241] op_sel_hi:[1,0]
    v_cvt_pk_bf16_f32 v54, v44, v45
    v_cvt_pk_bf16_f32 v55, v46, v47
    s_nop 0
    v_permlane16_swap_b32 v52, v54
    v_permlane16_swap_b32 v53, v55
    buffer_store_dwordx4 v[52:55], v60, s[72:75], s16 offen sc1
    buffer_load_dword v10, v76, s[72:75], s99 offen sc1
    s_add_u32 m0, s81, 0
    s_add_u32 s22, s91, 0
    buffer_load_dwordx4 v57, s[92:95], s22 offen lds
    s_add_u32 m0, s81, 1024
    s_add_u32 s22, s91, 0
    buffer_load_dwordx4 v58, s[92:95], s22 offen lds
    s_add_u32 m0, s81, 2048
    s_add_u32 s22, s91, 0
    buffer_load_dwordx4 v59, s[92:95], s22 offen lds
    s_add_u32 m0, s81, 12416
    s_add_u32 s22, s91, 88064
    buffer_load_dwordx4 v57, s[92:95], s22 offen lds
    s_add_u32 m0, s81, 13440
    s_add_u32 s22, s91, 88064
    buffer_load_dwordx4 v58, s[92:95], s22 offen lds
    s_add_u32 m0, s81, 14464
    s_add_u32 s22, s91, 88064
    buffer_load_dwordx4 v59, s[92:95], s22 offen lds
    s_add_u32 m0, s81, 24832
    s_add_u32 s22, s91, 176128
    buffer_load_dwordx4 v57, s[92:95], s22 offen lds
    s_add_u32 m0, s81, 25856
    s_add_u32 s22, s91, 176128
    buffer_load_dwordx4 v58, s[92:95], s22 offen lds
    s_waitcnt vmcnt(11)
    s_branch L_c_10
L_p_11:
    buffer_load_dword v77, v76, s[72:75], s84 offen sc1
    s_waitcnt vmcnt(0)
L_c_10:
    v_xor_b32 v6, s8, v77
    v_lshrrev_b32 v6, 4, v6
    v_cmp_ne_u32 vcc, 0, v6
    s_nop 1
    s_and_b64 vcc, vcc, 0xffff
    s_cbranch_vccz L_d_12
    s_sub_u32 s87, s87, 1
    s_cmp_eq_u32 s87, 0
    s_cbranch_scc1 L_giveup
    s_branch L_p_11
L_d_12:
    v_and_b32 v5, 15, v77
    v_cmp_ne_u32 vcc, s11, v5
    s_nop 1
    s_and_b64 vcc, vcc, 0xffff
    s_cmp_eq_u64 vcc, 0
    s_cselect_b32 s9, 1, 0
    s_mul_i32 s12, s9, 131072
    s_sub_u32 s97, s97, s12
    s_sub_u32 s36, s36, s12
    v_permlane16_swap_b32 v88, v90
    v_permlane16_swap_b32 v89, v91
    v_permlane16_swap_b32 v92, v94
    v_permlane16_swap_b32 v93, v95
    s_add_u32 s17, s35, 4096
    s_add_u32 s18, s35, 8192
    s_add_u32 s19, s35, 12288
    v_lshrrev_b32_e64 v16, 2, v0
    v_mul_u32_u24 v16, 192, v16
    v_and_b32_e64 v4, 3, v0
    v_lshl_add_u32 v16, v4, 3, v16
    v_add_u32 v16, 12288, v16
    v_and_b32 v18, 1, v2
    v_xor_b32 v17, s4, v18
    s_lshr_b32 s13, s4, 1
    s_add_u32 s13, s13, 4
    v_xor_b32_e64 v18, s13, v18
    v_lshl_add_u32 v20, v17, 5, v16
    v_lshl_add_u32 v21, v18, 5, v16
    v_add_u32 v22, 37248, v20
    v_add_u32 v23, 37248, v21
    s_and_b32 s12, s4, 1
    s_lshl_b32 s12, s12, 12
    s_xor_b32 s13, s12, 4096
    s_add_u32 s12, s12, 94208
    s_add_u32 s13, s13, 94208
    v_add_u32 v13, s12, v1
    v_add_u32 v14, s13, v1
    s_add_u32 s12, s80, s84
    v_mov_b32 v5, s8
    s_and_b32 s13, s80, 32
    v_and_b32 v9, 7, v0
    v_lshl_add_u32 v9, v9, 2, s13
    s_waitcnt vmcnt(9)
    s_barrier
    s_cmp_lg_u32 s4, 0
    s_cbranch_scc1 L_pf_14
    s_mov_b64 exec, 1
    s_cmp_lg_u32 s9, 0
    s_cbranch_scc1 L_pf_13
    buffer_store_dword v5, off, s[72:75], s12 offset:64 sc1
    s_mov_b64 exec, -1
    s_branch L_pf_14
L_pf_13:
    buffer_store_dword v5, off, s[72:75], s12 offset:64
    s_mov_b64 exec, -1
L_pf_14:
    buffer_load_dword v8, v9, s[72:75], s84 offen offset:64 sc1
    buffer_load_dwordx4 v[64:67], v80, s[72:75], s24 offen sc1
    buffer_load_dwordx4 v[68:71], v80, s[72:75], s25 offen sc1
    buffer_load_dwordx4 v[72:75], v80, s[72:75], s26 offen sc1
    buffer_load_dwordx4 v[76:79], v80, s[72:75], s27 offen sc1
    ds_read_b64_tr_b16 a[96:97], v84 offset:16384
    ds_read_b64_tr_b16 a[98:99], v84 offset:16896
    ds_read_b64_tr_b16 a[100:101], v85 offset:16384
    ds_read_b64_tr_b16 a[102:103], v85 offset:16896
    ds_read_b64_tr_b16 a[104:105], v86 offset:16384
    ds_read_b64_tr_b16 a[106:107], v86 offset:16896
    ds_read_b64_tr_b16 a[108:109], v87 offset:16384
    ds_read_b64_tr_b16 a[110:111], v87 offset:16896
    ds_read_b64_tr_b16 a[112:113], v84 offset:20480
    ds_read_b64_tr_b16 a[114:115], v84 offset:20992
    ds_read_b64_tr_b16 a[116:117], v85 offset:20480
    ds_read_b64_tr_b16 a[118:119], v85 offset:20992
    ds_read_b64_tr_b16 a[120:121], v86 offset:20480
    ds_read_b64_tr_b16 a[122:123], v86 offset:20992
    ds_read_b64_tr_b16 a[124:125], v87 offset:20480
    ds_read_b64_tr_b16 a[126:127], v87 offset:20992
    ds_read_b64_tr_b16 a[128:129], v84 offset:24576
    ds_read_b64_tr_b16 a[130:131], v84 offset:25088
    ds_read_b64_tr_b16 a[132:133], v85 offset:24576
    ds_read_b64_tr_b16 a[134:135], v85 offset:25088
    ds_read_b64_tr_b16 a[136:137], v86 offset:24576
    ds_read_b64_tr_b16 a[138:139], v86 offset:25088
    ds_read_b64_tr_b16 a[140:141], v87 offset:24576
    ds_read_b64_tr_b16 a[142:143], v87 offset:25088
    ds_read_b64_tr_b16 a[144:145], v84 offset:28672
    ds_read_b64_tr_b16 a[146:147], v84 offset:29184
    ds_read_b64_tr_b16 a[148:149], v85 offset:28672
    ds_read_b64_tr_b16 a[150:151], v85 offset:29184
    ds_read_b64_tr_b16 a[152:153], v86 offset:28672
    ds_read_b64_tr_b16 a[154:155], v86 offset:29184
    ds_read_b64_tr_b16 a[156:157], v87 offset:28672
    ds_read_b64_tr_b16 a[158:159], v87 offset:29184
    ds_read_b64_tr_b16 a[160:161], v84 offset:32768
    ds_read_b64_tr_b16 a[162:163], v84 offset:33280
    ds_read_b64_tr_b16 a[164:165], v85 offset:32768
    ds_read_b64_tr_b16 a[166:167], v85 offset:33280
    ds_read_b64_tr_b16 a[168:169], v86 offset:32768
    ds_read_b64_tr_b16 a[170:171], v86 offset:33280
    ds_read_b64_tr_b16 a[172:173], v87 offset:32768
    ds_read_b64_tr_b16 a[174:175], v87 offset:33280
    ds_read_b64_tr_b16 a[176:177], v84 offset:36864
    ds_read_b64_tr_b16 a[178:179], v84 offset:37376
    ds_read_b64_tr_b16 a[180:181], v85 offset:36864
    ds_read_b64_tr_b16 a[182:183], v85 offset:37376
    ds_read_b64_tr_b16 a[184:185], v86 offset:36864
    ds_read_b64_tr_b16 a[186:187], v86 offset:37376
    ds_read_b64_tr_b16 a[188:189], v87 offset:36864
    ds_read_b64_tr_b16 a[190:191], v87 offset:37376
    ds_read_b64_tr_b16 a[192:193], v84 offset:40960
    ds_read_b64_tr_b16 a[194:195], v84 offset:41472
    ds_read_b64_tr_b16 a[196:197], v85 offset:40960
    ds_read_b64_tr_b16 a[198:199], v85 offset:41472
    ds_read_b64_tr_b16 a[200:201], v86 offset:40960
    ds_read_b64_tr_b16 a[202:203], v86 offset:41472
    ds_read_b64_tr_b16 a[204:205], v87 offset:40960
    ds_read_b64_tr_b16 a[206:207], v87 offset:41472
    ds_read_b64_tr_b16 a[208:209], v84 offset:45056
    ds_read_b64_tr_b16 a[210:211], v84 offset:45568
    ds_read_b64_tr_b16 a[212:213], v85 offset:45056
    ds_read_b64_tr_b16 a[214:215], v85 offset:45568
    ds_read_b64_tr_b16 a[216:217], v86 offset:45056
    ds_read_b64_tr_b16 a[218:219], v86 offset:45568
    ds_read_b64_tr_b16 a[220:221], v87 offset:45056
    ds_read_b64_tr_b16 a[222:223], v87 offset:45568
    s_waitcnt vmcnt(4)
    s_branch L_c_15
L_p_16:
    buffer_load_dword v8, v9, s[72:75], s84 offen offset:64 sc1
    s_waitcnt vmcnt(0)
L_c_15:
    v_cmp_ne_u32 vcc, s8, v8
    s_nop 1
    s_cbranch_vccz L_d_17
    s_sub_u32 s87, s87, 1
    s_cmp_eq_u32 s87, 0
    s_cbranch_scc1 L_giveup
    s_branch L_p_16
L_d_17:
    ds_read_b64_tr_b16 a[224:225], v84 offset:49152
    buffer_load_dwordx4 v[96:99], v1, s[72:75], s17 offen offset:0 sc1
    ds_read_b64_tr_b16 a[226:227], v84 offset:49664
    ds_read_b64_tr_b16 a[228:229], v85 offset:49152
    ds_read_b64_tr_b16 a[230:231], v85 offset:49664
    ds_read_b64_tr_b16 a[232:233], v86 offset:49152
    ds_read_b64_tr_b16 a[234:235], v86 offset:49664
    buffer_load_dwordx4 v[100:103], v1, s[72:75], s17 offen offset:1024 sc1
    ds_read_b64_tr_b16 a[236:237], v87 offset:49152
    ds_read_b64_tr_b16 a[238:239], v87 offset:49664
    ds_read_b64_tr_b16 a[240:241], v84 offset:53248
    ds_read_b64_tr_b16 a[242:243], v84 offset:53760
    ds_read_b64_tr_b16 a[244:245], v85 offset:53248
    buffer_load_dwordx4 v[104:107], v1, s[72:75], s17 offen offset:2048 sc1
    ds_read_b64_tr_b16 a[246:247], v85 offset:53760
    ds_read_b64_tr_b16 a[248:249], v86 offset:53248
    ds_read_b64_tr_b16 a[250:251], v86 offset:53760
    ds_read_b64_tr_b16 a[252:253], v87 offset:53248
    ds_read_b64_tr_b16 a[254:255], v87 offset:53760
    ds_read_b64_tr_b16 v[224:225], v84 offset:57344
    buffer_load_dwordx4 v[108:111], v1, s[72:75], s17 offen offset:3072 sc1
    ds_read_b64_tr_b16 v[226:227], v84 offset:57856
    ds_read_b64_tr_b16 v[228:229], v85 offset:57344
    ds_read_b64_tr_b16 v[230:231], v85 offset:57856
    ds_read_b64_tr_b16 v[232:233], v86 offset:57344
    ds_read_b64_tr_b16 v[234:235], v86 offset:57856
    buffer_load_dwordx4 v[112:115], v1, s[72:75], s18 offen offset:0 sc1
    ds_read_b64_tr_b16 v[236:237], v87 offset:57344
    ds_read_b64_tr_b16 v[238:239], v87 offset:57856
    ds_read_b64_tr_b16 v[240:241], v84 offset:61440
    ds_read_b64_tr_b16 v[242:243], v84 offset:61952
    ds_read_b64_tr_b16 v[244:245], v85 offset:61440
    buffer_load_dwordx4 v[116:119], v1, s[72:75], s18 offen offset:1024 sc1
    ds_read_b64_tr_b16 v[246:247], v85 offset:61952
    ds_read_b64_tr_b16 v[248:249], v86 offset:61440
    ds_read_b64_tr_b16 v[250:251], v86 offset:61952
    ds_read_b64_tr_b16 v[252:253], v87 offset:61440
    ds_read_b64_tr_b16 v[254:255], v87 offset:61952
    ds_read_b64_tr_b16 v[160:161], v84 offset:0
    buffer_load_dwordx4 v[120:123], v1, s[72:75], s18 offen offset:2048 sc1
    ds_read_b64_tr_b16 v[162:163], v84 offset:512
    ds_read_b64_tr_b16 v[164:165], v85 offset:0
    ds_read_b64_tr_b16 v[166:167], v85 offset:512
    ds_read_b64_tr_b16 v[168:169], v86 offset:0
    ds_read_b64_tr_b16 v[170:171], v86 offset:512
    buffer_load_dwordx4 v[124:127], v1, s[72:75], s18 offen offset:3072 sc1
    ds_read_b64_tr_b16 v[172:173], v87 offset:0
    ds_read_b64_tr_b16 v[174:175], v87 offset:512
    ds_read_b64_tr_b16 v[176:177], v84 offset:4096
    ds_read_b64_tr_b16 v[178:179], v84 offset:4608
    ds_read_b64_tr_b16 v[180:181], v85 offset:4096
    buffer_load_dwordx4 v[128:131], v1, s[72:75], s19 offen offset:0 sc1
    ds_read_b64_tr_b16 v[182:183], v85 offset:4608
    ds_read_b64_tr_b16 v[184:185], v86 offset:4096
    ds_read_b64_tr_b16 v[186:187], v86 offset:4608
    ds_read_b64_tr_b16 v[188:189], v87 offset:4096
    ds_read_b64_tr_b16 v[190:191], v87 offset:4608
    ds_read_b64_tr_b16 v[192:193], v84 offset:8192
    buffer_load_dwordx4 v[132:135], v1, s[72:75], s19 offen offset:1024 sc1
    ds_read_b64_tr_b16 v[194:195], v84 offset:8704
    ds_read_b64_tr_b16 v[196:197], v85 offset:8192
    ds_read_b64_tr_b16 v[198:199], v85 offset:8704
    ds_read_b64_tr_b16 v[200:201], v86 offset:8192
    ds_read_b64_tr_b16 v[202:203], v86 offset:8704
    buffer_load_dwordx4 v[136:139], v1, s[72:75], s19 offen offset:2048 sc1
    ds_read_b64_tr_b16 v[204:205], v87 offset:8192
    ds_read_b64_tr_b16 v[206:207], v87 offset:8704
    ds_read_b64_tr_b16 v[208:209], v84 offset:12288
    ds_read_b64_tr_b16 v[210:211], v84 offset:12800
    ds_read_b64_tr_b16 v[212:213], v85 offset:12288
    buffer_load_dwordx4 v[140:143], v1, s[72:75], s19 offen offset:3072 sc1
    ds_read_b64_tr_b16 v[214:215], v85 offset:12800
    ds_read_b64_tr_b16 v[216:217], v86 offset:12288
    ds_read_b64_tr_b16 v[218:219], v86 offset:12800
    ds_read_b64_tr_b16 v[220:221], v87 offset:12288
    ds_read_b64_tr_b16 v[222:223], v87 offset:12800
    s_waitcnt vmcnt(12)
    s_branch L_c_18
L_p_19:
    buffer_load_dwordx4 v[64:67], v80, s[72:75], s24 offen sc1
    buffer_load_dwordx4 v[68:71], v80, s[72:75], s25 offen sc1
    buffer_load_dwordx4 v[72:75], v80, s[72:75], s26 offen sc1
    buffer_load_dwordx4 v[76:79], v80, s[72:75], s27 offen sc1
    s_waitcnt vmcnt(0)
L_c_18:
    s_and_b32 s13, s8, 0xff
    v_xor_b32 v64, s13, v64
    v_xor_b32 v65, s13, v65
    v_xor_b32 v66, s13, v66
    v_xor_b32 v67, s13, v67
    v_xor_b32 v68, s13, v68
    v_xor_b32 v69, s13, v69
    v_xor_b32 v70, s13, v70
    v_xor_b32 v71, s13, v71
    v_xor_b32 v72, s13, v72
    v_xor_b32 v73, s13, v73
    v_xor_b32 v74, s13, v74
    v_xor_b32 v75, s13, v75
    v_xor_b32 v76, s13, v76
    v_xor_b32 v77, s13, v77
    v_xor_b32 v78, s13, v78
    v_xor_b32_e64 v79, s13, v79
    v_or3_b32 v5, v64, v65, v66
    v_or3_b32 v6, v67, v68, v69
    v_or3_b32 v5, v5, v70, v71
    v_or3_b32 v6, v6, v72, v73
    v_or3_b32 v5, v5, v74, v75
    v_or3_b32 v6, v6, v76, v77
    v_or3_b32 v5, v5, v78, v79
    v_or_b32_e64 v5, v5, v6
    v_and_b32 v5, 0xff, v5
    v_cmp_ne_u32_e64 vcc, 0, v5
    s_nop 1
    s_cbranch_vccz L_d_20
    s_sub_u32 s87, s87, 1
    s_cmp_eq_u32 s87, 0
    s_cbranch_scc1 L_giveup
    s_branch L_p_19
L_d_20:
    v_pk_add_f32 v[64:65], v[64:65], v[68:69]
    v_pk_add_f32 v[72:73], v[72:73], v[76:77]
    v_pk_add_f32 v[66:67], v[66:67], v[70:71]
    v_pk_add_f32 v[74:75], v[74:75], v[78:79]
    v_pk_add_f32 v[64:65], v[64:65], v[72:73]
    v_pk_add_f32 v[66:67], v[66:67], v[74:75]
    v_cvt_pk_bf16_f32 v5, v64, v65
    v_cvt_pk_bf16_f32 v6, v66, v67
    v_lshlrev_b32 v64, 16, v5
    v_and_b32 v65, s86, v5
    v_lshlrev_b32 v66, 16, v6
    v_and_b32 v67, s86, v6
    v_add_f32 v64, v64, v83
    v_add_f32 v65, v65, v83
    v_add_f32 v66, v66, v83
    v_add_f32 v67, v67, v83
    v_cvt_pk_bf16_f32 v5, v64, v65
    v_cvt_pk_bf16_f32 v6, v66, v67
    v_lshlrev_b32 v64, 16, v5
    v_and_b32 v65, s86, v5
    v_lshlrev_b32 v66, 16, v6
    v_and_b32 v67, s86, v6
    ds_write_b128 v82, v[64:67]
    ds_read_b128 v[32:35], v63 offset:0
    ds_read_b128 v[36:39], v63 offset:64
    ds_read_b128 v[40:43], v63 offset:128
    ds_read_b128 v[44:47], v63 offset:192
    s_barrier
    s_waitcnt vmcnt(11)
    s_waitcnt lgkmcnt(15)
    v_mfma_f32_16x16x32_bf16 v[64:67], a[96:99], v[96:99], 0
    buffer_load_dwordx4 v[144:147], v1, s[72:75], s35 offen offset:0 sc1
    v_mfma_f32_16x16x32_bf16 v[68:71], a[100:103], v[96:99], 0
    v_mfma_f32_16x16x32_bf16 v[72:75], a[104:107], v[96:99], 0
    v_mfma_f32_16x16x32_bf16 v[76:79], a[108:111], v[96:99], 0
    s_waitcnt vmcnt(11)
    s_waitcnt lgkmcnt(15)
    v_mfma_f32_16x16x32_bf16 v[64:67], a[112:115], v[100:103], v[64:67]
    buffer_load_dwordx4 v[148:151], v1, s[72:75], s35 offen offset:1024 sc1
    v_mfma_f32_16x16x32_bf16 v[68:71], a[116:119], v[100:103], v[68:71]
    v_mfma_f32_16x16x32_bf16 v[72:75], a[120:123], v[100:103], v[72:75]
    v_mfma_f32_16x16x32_bf16 v[76:79], a[124:127], v[100:103], v[76:79]
    s_waitcnt vmcnt(11)
    s_waitcnt lgkmcnt(15)
    v_mfma_f32_16x16x32_bf16 v[64:67], a[128:131], v[104:107], v[64:67]
    buffer_load_dwordx4 v[152:155], v1, s[72:75], s35 offen offset:2048 sc1
    v_mfma_f32_16x16x32_bf16 v[68:71], a[132:135], v[104:107], v[68:71]
    v_mfma_f32_16x16x32_bf16 v[72:75], a[136:139], v[104:107], v[72:75]
    v_mfma_f32_16x16x32_bf16 v[76:79], a[140:143], v[104:107], v[76:79]
    s_waitcnt vmcnt(11)
    s_waitcnt lgkmcnt(15)
    v_mfma_f32_16x16x32_bf16 v[64:67], a[144:147], v[108:111], v[64:67]
    buffer_load_dwordx4 v[156:159], v1, s[72:75], s35 offen offset:3072 sc1
    v_mfma_f32_16x16x32_bf16 v[68:71], a[148:151], v[108:111], v[68:71]
    v_mfma_f32_16x16x32_bf16 v[72:75], a[152:155], v[108:111], v[72:75]
    v_mfma_f32_16x16x32_bf16 v[76:79], a[156:159], v[108:111], v[76:79]
    s_waitcnt vmcnt(11)
    s_waitcnt lgkmcnt(15)
    v_mfma_f32_16x16x32_bf16 v[64:67], a[160:163], v[112:115], v[64:67]
    ds_read_b64_tr_b16 a[0:1], v20 offset:0
    v_mfma_f32_16x16x32_bf16 v[68:71], a[164:167], v[112:115], v[68:71]
    ds_read_b64_tr_b16 a[2:3], v20 offset:3072
    v_mfma_f32_16x16x32_bf16 v[72:75], a[168:171], v[112:115], v[72:75]
    ds_read_b64_tr_b16 a[4:5], v20 offset:6176
    v_mfma_f32_16x16x32_bf16 v[76:79], a[172:175], v[112:115], v[76:79]
    ds_read_b64_tr_b16 a[6:7], v20 offset:9248
    s_waitcnt vmcnt(10)
    s_waitcnt lgkmcnt(15)
    v_mfma_f32_16x16x32_bf16 v[64:67], a[176:179], v[116:119], v[64:67]
    s_add_u32 m0, s81, 26880
    s_add_u32 s22, s91, 176128
    buffer_load_dwordx4 v59, s[92:95], s22 offen lds
    ds_read_b64_tr_b16 a[8:9], v21 offset:0
    v_mfma_f32_16x16x32_bf16 v[68:71], a[180:183], v[116:119], v[68:71]
    ds_read_b64_tr_b16 a[10:11], v21 offset:3072
    v_mfma_f32_16x16x32_bf16 v[72:75], a[184:187], v[116:119], v[72:75]
    ds_read_b64_tr_b16 a[12:13], v21 offset:6176
    v_mfma_f32_16x16x32_bf16 v[76:79], a[188:191], v[116:119], v[76:79]
    ds_read_b64_tr_b16 a[14:15], v21 offset:9248
    s_waitcnt vmcnt(10)
    s_waitcnt lgkmcnt(15)
    v_mfma_f32_16x16x32_bf16 v[64:67], a[192:195], v[120:123], v[64:67]
    s_add_u32 m0, s81, 37248
    s_add_u32 s22, s91, 264192
    buffer_load_dwordx4 v57, s[92:95], s22 offen lds
    ds_read_b64_tr_b16 a[16:17], v20 offset:12416
    v_mfma_f32_16x16x32_bf16 v[68:71], a[196:199], v[120:123], v[68:71]
    ds_read_b64_tr_b16 a[18:19], v20 offset:15488
    v_mfma_f32_16x16x32_bf16 v[72:75], a[200:203], v[120:123], v[72:75]
    ds_read_b64_tr_b16 a[20:21], v20 offset:18592
    v_mfma_f32_16x16x32_bf16 v[76:79], a[204:207], v[120:123], v[76:79]
    ds_read_b64_tr_b16 a[22:23], v20 offset:21664
    s_waitcnt vmcnt(10)
    s_waitcnt lgkmcnt(15)
    v_mfma_f32_16x16x32_bf16 v[64:67], a[208:211], v[124:127], v[64:67]
    ds_read_b64_tr_b16 a[24:25], v21 offset:12416
    v_mfma_f32_16x16x32_bf16 v[68:71], a[212:215], v[124:127], v[68:71]
    ds_read_b64_tr_b16 a[26:27], v21 offset:15488
    v_mfma_f32_16x16x32_bf16 v[72:75], a[216:219], v[124:127], v[72:75]
    ds_read_b64_tr_b16 a[28:29], v21 offset:18592
    v_mfma_f32_16x16x32_bf16 v[76:79], a[220:223], v[124:127], v[76:79]
    ds_read_b64_tr_b16 a[30:31], v21 offset:21664
    s_waitcnt vmcnt(9)
    s_waitcnt lgkmcnt(15)
    v_mfma_f32_16x16x32_bf16 v[64:67], a[224:227], v[128:131], v[64:67]
    s_add_u32 m0, s81, 38272
    s_add_u32 s22, s91, 264192
    buffer_load_dwordx4 v58, s[92:95], s22 offen lds
    v_mfma_f32_16x16x32_bf16 v[68:71], a[228:231], v[128:131], v[68:71]
    v_mfma_f32_16x16x32_bf16 v[72:75], a[232:235], v[128:131], v[72:75]
    v_mfma_f32_16x16x32_bf16 v[76:79], a[236:239], v[128:131], v[76:79]
    s_waitcnt vmcnt(9)
    s_waitcnt lgkmcnt(15)
    v_mfma_f32_16x16x32_bf16 v[64:67], a[240:243], v[132:135], v[64:67]
    s_add_u32 m0, s81, 39296
    s_add_u32 s22, s91, 264192
    buffer_load_dwordx4 v59, s[92:95], s22 offen lds
    v_mfma_f32_16x16x32_bf16 v[68:71], a[244:247], v[132:135], v[68:71]
    v_mfma_f32_16x16x32_bf16 v[72:75], a[248:251], v[132:135], v[72:75]
    v_mfma_f32_16x16x32_bf16 v[76:79], a[252:255], v[132:135], v[76:79]
    s_waitcnt vmcnt(9)
    s_waitcnt lgkmcnt(15)
    v_mfma_f32_16x16x32_bf16 v[64:67], v[224:227], v[136:139], v[64:67]
    s_add_u32 m0, s81, 49664
    s_add_u32 s22, s91, 352256
    buffer_load_dwordx4 v57, s[92:95], s22 offen lds
    v_mfma_f32_16x16x32_bf16 v[68:71], v[228:231], v[136:139], v[68:71]
    v_mfma_f32_16x16x32_bf16 v[72:75], v[232:235], v[136:139], v[72:75]
    v_mfma_f32_16x16x32_bf16 v[76:79], v[236:239], v[136:139], v[76:79]
    s_waitcnt vmcnt(9)
    s_waitcnt lgkmcnt(15)
    v_mfma_f32_16x16x32_bf16 v[64:67], v[240:243], v[140:143], v[64:67]
    v_mfma_f32_16x16x32_bf16 v[68:71], v[244:247], v[140:143], v[68:71]
    v_mfma_f32_16x16x32_bf16 v[72:75], v[248:251], v[140:143], v[72:75]
    v_mfma_f32_16x16x32_bf16 v[76:79], v[252:255], v[140:143], v[76:79]
    s_waitcnt vmcnt(8)
    s_waitcnt lgkmcnt(15)
    v_mfma_f32_16x16x32_bf16 v[64:67], v[160:163], v[144:147], v[64:67]
    v_mfma_f32_16x16x32_bf16 v[68:71], v[164:167], v[144:147], v[68:71]
    v_mfma_f32_16x16x32_bf16 v[72:75], v[168:171], v[144:147], v[72:75]
    v_mfma_f32_16x16x32_bf16 v[76:79], v[172:175], v[144:147], v[76:79]
    v_lshlrev_b32 v112, 16, v88
    v_and_b32 v113, s86, v88
    v_lshlrev_b32 v114, 16, v89
    v_and_b32 v115, s86, v89
    v_lshlrev_b32 v116, 16, v90
    v_and_b32 v117, s86, v90
    v_lshlrev_b32 v118, 16, v91
    v_and_b32 v119, s86, v91
    v_lshlrev_b32 v120, 16, v92
    v_and_b32 v121, s86, v92
    v_lshlrev_b32 v122, 16, v93
    v_and_b32 v123, s86, v93
    v_lshlrev_b32 v124, 16, v94
    v_and_b32 v125, s86, v94
    v_lshlrev_b32 v126, 16, v95
    v_and_b32_e64 v127, s86, v95
    s_waitcnt vmcnt(7)
    s_waitcnt lgkmcnt(15)
    v_mfma_f32_16x16x32_bf16 v[64:67], v[176:179], v[148:151], v[64:67]
    s_add_u32 m0, s81, 50688
    s_add_u32 s22, s91, 352256
    buffer_load_dwordx4 v58, s[92:95], s22 offen lds
    v_mfma_f32_16x16x32_bf16 v[68:71], v[180:183], v[148:151], v[68:71]
    v_mfma_f32_16x16x32_bf16 v[72:75], v[184:187], v[148:151], v[72:75]
    v_mfma_f32_16x16x32_bf16 v[76:79], v[188:191], v[148:151], v[76:79]
    s_waitcnt vmcnt(7)
    s_waitcnt lgkmcnt(15)
    v_mfma_f32_16x16x32_bf16 v[64:67], v[192:195], v[152:155], v[64:67]
    s_add_u32 m0, s81, 51712
    s_add_u32 s22, s91, 352256
    buffer_load_dwordx4 v59, s[92:95], s22 offen lds
    v_mfma_f32_16x16x32_bf16 v[68:71], v[196:199], v[152:155], v[68:71]
    v_mfma_f32_16x16x32_bf16 v[72:75], v[200:203], v[152:155], v[72:75]
    v_mfma_f32_16x16x32_bf16 v[76:79], v[204:207], v[152:155], v[76:79]
    s_waitcnt vmcnt(7)
    s_waitcnt lgkmcnt(15)
    v_mfma_f32_16x16x32_bf16 v[64:67], v[208:211], v[156:159], v[64:67]
    s_add_u32 m0, s81, 62080
    s_add_u32 s22, s91, 440320
    buffer_load_dwordx4 v57, s[92:95], s22 offen lds
    v_mfma_f32_16x16x32_bf16 v[68:71], v[212:215], v[156:159], v[68:71]
    v_mfma_f32_16x16x32_bf16 v[72:75], v[216:219], v[156:159], v[72:75]
    v_mfma_f32_16x16x32_bf16 v[76:79], v[220:223], v[156:159], v[76:79]
    s_waitcnt lgkmcnt(0)
    s_barrier
    v_pk_fma_f32 v[64:65], v[64:65], v[32:33], v[112:113]
    v_pk_fma_f32 v[66:67], v[66:67], v[34:35], v[114:115]
    s_nop 1
    v_pk_fma_f32 v[68:69], v[68:69], v[36:37], v[116:117]
    v_pk_fma_f32 v[70:71], v[70:71], v[38:39], v[118:119]
    v_pk_fma_f32 v[72:73], v[72:73], v[40:41], v[120:121]
    v_pk_fma_f32 v[74:75], v[74:75], v[42:43], v[122:123]
    v_pk_fma_f32 v[76:77], v[76:77], v[44:45], v[124:125]
    v_pk_fma_f32 v[78:79], v[78:79], v[46:47], v[126:127]
    v_cvt_pk_bf16_f32 v24, v64, v65
    v_cvt_pk_bf16_f32 v25, v66, v67
    v_cvt_pk_bf16_f32 v26, v68, v69
    v_cvt_pk_bf16_f32 v27, v70, v71
    v_cvt_pk_bf16_f32 v28, v72, v73
    v_cvt_pk_bf16_f32 v29, v74, v75
    v_cvt_pk_bf16_f32 v30, v76, v77
    v_cvt_pk_bf16_f32 v31, v78, v79
    v_dot2_f32_bf16 v48, v24, s85, 0
    v_dot2_f32_bf16 v49, v24, v24, 0
    v_dot2_f32_bf16 v48, v25, s85, v48
    v_dot2_f32_bf16 v49, v25, v25, v49
    v_dot2_f32_bf16 v48, v26, s85, v48
    v_dot2_f32_bf16 v49, v26, v26, v49
    v_dot2_f32_bf16 v48, v27, s85, v48
    v_dot2_f32_bf16 v49, v27, v27, v49
    v_dot2_f32_bf16 v48, v28, s85, v48
    v_dot2_f32_bf16 v49, v28, v28, v49
    v_dot2_f32_bf16 v48, v29, s85, v48
    v_dot2_f32_bf16 v49, v29, v29, v49
    v_dot2_f32_bf16 v48, v30, s85, v48
    v_dot2_f32_bf16 v49, v30, v30, v49
    v_dot2_f32_bf16 v48, v31, s85, v48
    v_dot2_f32_bf16 v49, v31, v31, v49
    v_mov_b32 v50, s8
    v_mov_b32 v51, s8
    s_nop 0
    v_permlane32_swap_b32 v48, v49
    v_add_f32 v48, v48, v49
    v_mov_b32 v49, v48
    s_nop 1
    v_permlane16_swap_b32 v48, v49
    v_add_f32 v48, v48, v49
    v_mov_b32_e64 v49, v48
    s_nop 1
    v_permlane32_swap_b32 v48, v49
    s_mov_b64 exec, 0xffff
    s_cmp_lg_u32 s9, 0
    s_cbranch_scc1 L_st_21
    buffer_store_dwordx4 v[48:51], v1, s[72:75], s99 offen sc1
    s_branch L_st_22
L_st_21:
    buffer_store_dwordx4 v[48:51], v1, s[72:75], s99 offen
L_st_22:
    s_mov_b64 exec, -1
    s_add_u32 m0, s81, 63104
    s_add_u32 s22, s91, 440320
    buffer_load_dwordx4 v58, s[92:95], s22 offen lds
    s_add_u32 m0, s81, 64128
    s_add_u32 s22, s91, 440320
    buffer_load_dwordx4 v59, s[92:95], s22 offen lds
    s_add_u32 m0, s81, 0
    s_add_u32 s22, s91, 528384
    buffer_load_dwordx4 v57, s[92:95], s22 offen lds
    s_add_u32 m0, s81, 1024
    s_add_u32 s22, s91, 528384
    buffer_load_dwordx4 v58, s[92:95], s22 offen lds
    v_lshlrev_b32 v64, 16, v24
    v_and_b32 v65, s86, v24
    v_lshlrev_b32 v66, 16, v25
    v_and_b32 v67, s86, v25
    v_lshlrev_b32 v68, 16, v26
    v_and_b32 v69, s86, v26
    v_lshlrev_b32 v70, 16, v27
    v_and_b32 v71, s86, v27
    v_lshlrev_b32 v72, 16, v28
    v_and_b32 v73, s86, v28
    v_lshlrev_b32 v74, 16, v29
    v_and_b32 v75, s86, v29
    v_lshlrev_b32 v76, 16, v30
    v_and_b32 v77, s86, v30
    v_lshlrev_b32 v78, 16, v31
    v_and_b32_e64 v79, s86, v31
    ds_read_b128 v[112:115], v63 offset:256
    ds_read_b128 v[128:131], v63 offset:512
    ds_read_b128 v[32:35], v63 offset:768
    ds_read_b128 v[116:119], v63 offset:320
    ds_read_b128 v[132:135], v63 offset:576
    ds_read_b128 v[36:39], v63 offset:832
    ds_read_b128 v[120:123], v63 offset:384
    ds_read_b128 v[136:139], v63 offset:640
    ds_read_b128 v[40:43], v63 offset:896
    ds_read_b128 v[124:127], v63 offset:448
    ds_read_b128 v[140:143], v63 offset:704
    ds_read_b128 v[44:47], v63 offset:960
    buffer_load_dwordx4 v[144:147], v1, s[72:75], s37 offen offset:0 sc1
    buffer_load_dwordx4 v[148:151], v1, s[72:75], s37 offen offset:1024 sc1
    s_add_u32 m0, s81, 2048
    s_add_u32 s22, s91, 528384
    buffer_load_dwordx4 v59, s[92:95], s22 offen lds
    s_add_u32 m0, s81, 12416
    s_add_u32 s22, s91, 616448
    buffer_load_dwordx4 v57, s[92:95], s22 offen lds
    s_add_u32 m0, s81, 13440
    s_add_u32 s22, s91, 616448
    buffer_load_dwordx4 v58, s[92:95], s22 offen lds
    s_add_u32 m0, s81, 14464
    s_add_u32 s22, s91, 616448
    buffer_load_dwordx4 v59, s[92:95], s22 offen lds
    s_waitcnt vmcnt(4)
    s_branch L_c_23
L_p_24:
    buffer_load_dwordx4 v[144:147], v1, s[72:75], s37 offen offset:0 sc1
    buffer_load_dwordx4 v[148:151], v1, s[72:75], s37 offen offset:1024 sc1
    s_waitcnt vmcnt(0)
L_c_23:
    v_cmp_ne_u32 vcc, s8, v146
    v_cmp_ne_u32 s[12:13], s8, v150
    s_nop 1
    s_or_b64 vcc, vcc, s[12:13]
    s_cbranch_vccz L_d_25
    s_sub_u32 s87, s87, 1
    s_cmp_eq_u32 s87, 0
    s_cbranch_scc1 L_giveup
    s_branch L_p_24
L_d_25:
    v_pk_add_f32 v[144:145], v[144:145], v[148:149]
    s_nop 1
    v_permlane32_swap_b32 v144, v145
    v_add_f32 v144, v144, v145
    v_mov_b32 v145, v144
    s_nop 1
    v_permlane16_swap_b32 v144, v145
    v_add_f32 v144, v144, v145
    v_mov_b32_e64 v145, v144
    s_nop 1
    v_permlane32_swap_b32 v144, v145
    s_mov_b32 s12, 0x3b000000
    v_pk_mul_f32 v[144:145], v[144:145], s[12:13] op_sel_hi:[1,0]
    v_fma_f32 v145, -v144, v144, v145
    v_max_f32_e64 v145, 0, v145
    v_add_f32 v145, 0x3727c5ac, v145
    v_rsq_f32 v146, v145
    s_nop 0
    v_mul_f32 v147, -v144, v146
    s_waitcnt lgkmcnt(0)
    v_pk_fma_f32 v[64:65], v[64:65], v[146:147], v[146:147] op_sel:[0,0,1] op_sel_hi:[1,0,1]
    v_pk_fma_f32 v[66:67], v[66:67], v[146:147], v[146:147] op_sel:[0,0,1] op_sel_hi:[1,0,1]
    v_pk_fma_f32 v[68:69], v[68:69], v[146:147], v[146:147] op_sel:[0,0,1] op_sel_hi:[1,0,1]
    v_pk_fma_f32 v[70:71], v[70:71], v[146:147], v[146:147] op_sel:[0,0,1] op_sel_hi:[1,0,1]
    v_pk_fma_f32 v[64:65], v[64:65], v[128:129], v[112:113]
    v_pk_fma_f32 v[66:67], v[66:67], v[130:131], v[114:115]
    v_pk_fma_f32 v[68:69], v[68:69], v[132:133], v[116:117]
    v_pk_fma_f32 v[70:71], v[70:71], v[134:135], v[118:119]
    v_cvt_pk_bf16_f32 v96, v64, v65
    v_cvt_pk_bf16_f32 v97, v66, v67
    v_cvt_pk_bf16_f32 v98, v68, v69
    v_cvt_pk_bf16_f32 v99, v70, v71
    s_cmp_lg_u32 s9, 0
    s_cbranch_scc1 L_st_26
    buffer_store_dwordx4 v[96:99], v1, s[72:75], s97 offen offset:0 sc1
    s_branch L_st_27
L_st_26:
    buffer_store_dwordx4 v[96:99], v1, s[72:75], s97 offen offset:0
L_st_27:
    v_pk_fma_f32 v[72:73], v[72:73], v[146:147], v[146:147] op_sel:[0,0,1] op_sel_hi:[1,0,1]
    v_pk_fma_f32 v[74:75], v[74:75], v[146:147], v[146:147] op_sel:[0,0,1] op_sel_hi:[1,0,1]
    v_pk_fma_f32 v[76:77], v[76:77], v[146:147], v[146:147] op_sel:[0,0,1] op_sel_hi:[1,0,1]
    v_pk_fma_f32 v[78:79], v[78:79], v[146:147], v[146:147] op_sel:[0,0,1] op_sel_hi:[1,0,1]
    v_pk_fma_f32 v[72:73], v[72:73], v[136:137], v[120:121]
    v_pk_fma_f32 v[74:75], v[74:75], v[138:139], v[122:123]
    v_pk_fma_f32 v[76:77], v[76:77], v[140:141], v[124:125]
    v_pk_fma_f32 v[78:79], v[78:79], v[142:143], v[126:127]
    v_cvt_pk_bf16_f32 v100, v72, v73
    v_cvt_pk_bf16_f32 v101, v74, v75
    v_cvt_pk_bf16_f32 v102, v76, v77
    v_cvt_pk_bf16_f32 v103, v78, v79
    s_cmp_lg_u32 s9, 0
    s_cbranch_scc1 L_st_28
    buffer_store_dwordx4 v[100:103], v1, s[72:75], s97 offen offset:1024 sc1
    s_branch L_st_29
L_st_28:
    buffer_store_dwordx4 v[100:103], v1, s[72:75], s97 offen offset:1024
L_st_29:
    s_add_u32 s12, s80, s84
    v_mov_b32 v5, s8
    v_lshlrev_b32_e64 v9, 2, v3
    s_waitcnt vmcnt(0)
    s_barrier
    s_cmp_lg_u32 s4, 0
    s_cbranch_scc1 L_pf_31
    s_mov_b64 exec, 1
    s_cmp_lg_u32 s9, 0
    s_cbranch_scc1 L_pf_30
    buffer_store_dword v5, off, s[72:75], s12 offset:128 sc1
    s_mov_b64 exec, -1
    s_branch L_pf_31
L_pf_30:
    buffer_store_dword v5, off, s[72:75], s12 offset:128
    s_mov_b64 exec, -1
L_pf_31:
    buffer_load_dword v8, v9, s[72:75], s84 offen offset:128 sc1
    ds_read_b64_tr_b16 a[32:33], v20 offset:24832
    ds_read_b64_tr_b16 a[34:35], v20 offset:27904
    ds_read_b64_tr_b16 a[36:37], v20 offset:31008
    ds_read_b64_tr_b16 a[38:39], v20 offset:34080
    ds_read_b64_tr_b16 a[40:41], v21 offset:24832
    ds_read_b64_tr_b16 a[42:43], v21 offset:27904
    ds_read_b64_tr_b16 a[44:45], v21 offset:31008
    ds_read_b64_tr_b16 a[46:47], v21 offset:34080
    ds_read_b64_tr_b16 a[48:49], v22 offset:0
    ds_read_b64_tr_b16 a[50:51], v22 offset:3072
    ds_read_b64_tr_b16 a[52:53], v22 offset:6176
    ds_read_b64_tr_b16 a[54:55], v22 offset:9248
    ds_read_b64_tr_b16 a[56:57], v23 offset:0
    ds_read_b64_tr_b16 a[58:59], v23 offset:3072
    ds_read_b64_tr_b16 a[60:61], v23 offset:6176
    ds_read_b64_tr_b16 a[62:63], v23 offset:9248
    ds_read_b64_tr_b16 a[64:65], v22 offset:12416
    ds_read_b64_tr_b16 a[66:67], v22 offset:15488
    ds_read_b64_tr_b16 a[68:69], v22 offset:18592
    ds_read_b64_tr_b16 a[70:71], v22 offset:21664
    ds_read_b64_tr_b16 a[72:73], v23 offset:12416
    ds_read_b64_tr_b16 a[74:75], v23 offset:15488
    ds_read_b64_tr_b16 a[76:77], v23 offset:18592
    ds_read_b64_tr_b16 a[78:79], v23 offset:21664
    ds_read_b64_tr_b16 a[80:81], v22 offset:24832
    ds_read_b64_tr_b16 a[82:83], v22 offset:27904
    ds_read_b64_tr_b16 a[84:85], v22 offset:31008
    ds_read_b64_tr_b16 a[86:87], v22 offset:34080
    ds_read_b64_tr_b16 a[88:89], v23 offset:24832
    ds_read_b64_tr_b16 a[90:91], v23 offset:27904
    ds_read_b64_tr_b16 a[92:93], v23 offset:31008
    ds_read_b64_tr_b16 a[94:95], v23 offset:34080
    ds_read_b64_tr_b16 a[96:97], v20 offset:0
    ds_read_b64_tr_b16 a[98:99], v20 offset:3072
    ds_read_b64_tr_b16 a[100:101], v20 offset:6176
    ds_read_b64_tr_b16 a[102:103], v20 offset:9248
    ds_read_b64_tr_b16 a[104:105], v21 offset:0
    ds_read_b64_tr_b16 a[106:107], v21 offset:3072
    ds_read_b64_tr_b16 a[108:109], v21 offset:6176
    ds_read_b64_tr_b16 a[110:111], v21 offset:9248
    ds_read_b64_tr_b16 a[112:113], v20 offset:12416
    ds_read_b64_tr_b16 a[114:115], v20 offset:15488
    ds_read_b64_tr_b16 a[116:117], v20 offset:18592
    ds_read_b64_tr_b16 a[118:119], v20 offset:21664
    ds_read_b64_tr_b16 a[120:121], v21 offset:12416
    ds_read_b64_tr_b16 a[122:123], v21 offset:15488
    ds_read_b64_tr_b16 a[124:125], v21 offset:18592
    ds_read_b64_tr_b16 a[126:127], v21 offset:21664
    s_xor_b32 s12, s4, 3
    s_or_b32 s12, s2, s12
    s_cmp_lg_u32 s12, 0
    s_cbranch_scc1 L_ep_32
    v_lshrrev_b32 v4, 2, v0
    v_lshlrev_b32 v4, 20, v4
    v_and_b32 v5, 3, v0
    v_lshl_add_u32 v4, v5, 4, v4
    s_mov_b32 s12, 983040
L_epp_33:
    buffer_load_dwordx4 v[200:203], v4, s[72:75], s12 offen sc1
    s_waitcnt vmcnt(0)
    v_xor_b32 v200, s8, v200
    v_xor_b32 v201, s8, v201
    v_xor_b32 v202, s8, v202
    v_xor_b32_e64 v203, s8, v203
    v_or3_b32 v5, v200, v201, v202
    v_or_b32 v5, v5, v203
    v_lshrrev_b32 v5, 4, v5
    v_cmp_ne_u32 vcc, 0, v5
    s_nop 1
    s_cbranch_vccz L_eok_34
    s_sub_u32 s87, s87, 1
    s_cmp_eq_u32 s87, 0
    s_cbranch_scc1 L_giveup
    s_branch L_epp_33
L_eok_34:
    v_mov_b32_e64 v5, s8
    s_mov_b64 exec, 1
    s_mov_b32 s12, 978944
    buffer_store_dword v5, off, s[72:75], s12 sc1
    s_mov_b64 exec, -1
L_ep_32:
    v_mov_b32 v12, v81
    s_waitcnt vmcnt(0)
    s_branch L_c_35
L_p_36:
    buffer_load_dword v8, v9, s[72:75], s84 offen offset:128 sc1
    s_waitcnt vmcnt(0)
L_c_35:
    v_cmp_ne_u32 vcc, s8, v8
    s_nop 1
    s_cbranch_vccz L_d_37
    s_sub_u32 s87, s87, 1
    s_cmp_eq_u32 s87, 0
    s_cbranch_scc1 L_giveup
    s_branch L_p_36
L_d_37:
    s_add_u32 m0, s39, 0
    s_add_u32 s22, s36, 0
    buffer_load_dwordx4 v1, s[72:75], s22 offen sc1 lds
    s_add_u32 m0, s39, 1024
    s_add_u32 s22, s36, 16384
    buffer_load_dwordx4 v1, s[72:75], s22 offen sc1 lds
    s_add_u32 m0, s39, 2048
    s_add_u32 s22, s36, 32768
    buffer_load_dwordx4 v1, s[72:75], s22 offen sc1 lds
    s_add_u32 m0, s39, 3072
    s_add_u32 s22, s36, 49152
    buffer_load_dwordx4 v1, s[72:75], s22 offen sc1 lds
    s_add_u32 m0, s39, 16384
    s_add_u32 s22, s36, 2048
    buffer_load_dwordx4 v1, s[72:75], s22 offen sc1 lds
    s_add_u32 m0, s39, 17408
    s_add_u32 s22, s36, 18432
    buffer_load_dwordx4 v1, s[72:75], s22 offen sc1 lds
    s_add_u32 m0, s39, 18432
    s_add_u32 s22, s36, 34816
    buffer_load_dwordx4 v1, s[72:75], s22 offen sc1 lds
    s_add_u32 m0, s39, 19456
    s_add_u32 s22, s36, 51200
    buffer_load_dwordx4 v1, s[72:75], s22 offen sc1 lds
    v_add_u32 v16, 4294873088, v84
    v_add_u32 v17, 4294873088, v85
    v_add_u32 v18, 4294873088, v86
    v_add_u32 v19, 4294873088, v87
    v_add_u32 v48, 0x10000, v16
    v_add_u32 v52, 0x20000, v16
    v_add_u32 v49, 0x10000, v17
    v_add_u32 v53, 0x20000, v17
    v_add_u32 v50, 0x10000, v18
    v_add_u32 v54, 0x20000, v18
    v_add_u32 v51, 0x10000, v19
    v_add_u32 v55, 0x20000, v19
    s_lshr_b32 s14, s4, 1
    s_add_u32 s14, s14, 4
    s_sub_u32 s14, s14, s4
    s_lshl_b32 s14, s14, 10
    s_sub_u32 s13, s89, 2
    s_mul_i32 s14, s14, s13
    s_add_u32 s18, s98, s14
    s_add_u32 m0, s39, 32768
    s_add_u32 s22, s36, 4096
    buffer_load_dwordx4 v1, s[72:75], s22 offen sc1 lds
    s_add_u32 m0, s39, 33792
    s_add_u32 s22, s36, 20480
    buffer_load_dwordx4 v1, s[72:75], s22 offen sc1 lds
    s_add_u32 m0, s39, 34816
    s_add_u32 s22, s36, 36864
    buffer_load_dwordx4 v1, s[72:75], s22 offen sc1 lds
    s_add_u32 m0, s39, 35840
    s_add_u32 s22, s36, 53248
    buffer_load_dwordx4 v1, s[72:75], s22 offen sc1 lds
    s_add_u32 m0, s39, 49152
    s_add_u32 s22, s36, 6144
    buffer_load_dwordx4 v1, s[72:75], s22 offen sc1 lds
    s_waitcnt vmcnt(9)
    s_waitcnt lgkmcnt(0)
    s_barrier
    s_mov_b32 s14, 0xbfb8aa3b
    s_add_u32 s16, s98, 88064
    s_add_u32 s17, s83, 88064
    s_add_u32 s19, s18, 88064
    ds_read_b128 v[160:163], v13 offset:0
    s_add_u32 m0, s39, 50176
    s_add_u32 s22, s36, 22528
    buffer_load_dwordx4 v1, s[72:75], s22 offen sc1 lds
    ds_read_b128 v[164:167], v13 offset:8192
    ds_read_b128 v[168:171], v13 offset:1024
    ds_read_b128 v[172:175], v13 offset:9216
    ds_read_b128 v[176:179], v13 offset:2048
    ds_read_b128 v[180:183], v13 offset:10240
    ds_read_b128 v[184:187], v13 offset:3072
    ds_read_b128 v[188:191], v13 offset:11264
    s_waitcnt lgkmcnt(6)
    v_mfma_f32_16x16x32_bf16 v[64:67], a[0:3], v[160:163], 0
    ds_read_b128 v[192:195], v14 offset:0
    v_mfma_f32_16x16x32_bf16 v[64:67], a[16:19], v[164:167], v[64:67]
    ds_read_b128 v[196:199], v14 offset:8192
    v_mfma_f32_16x16x32_bf16 v[72:75], a[4:7], v[160:163], 0
    v_mfma_f32_16x16x32_bf16 v[72:75], a[20:23], v[164:167], v[72:75]
    s_add_u32 m0, s39, 51200
    s_add_u32 s22, s36, 38912
    buffer_load_dwordx4 v1, s[72:75], s22 offen sc1 lds
    v_mfma_f32_16x16x32_bf16 v[128:131], a[8:11], v[160:163], 0
    v_mfma_f32_16x16x32_bf16 v[128:131], a[24:27], v[164:167], v[128:131]
    v_mfma_f32_16x16x32_bf16 v[136:139], a[12:15], v[160:163], 0
    v_mfma_f32_16x16x32_bf16 v[136:139], a[28:31], v[164:167], v[136:139]
    s_waitcnt lgkmcnt(6)
    v_mfma_f32_16x16x32_bf16 v[68:71], a[0:3], v[168:171], 0
    s_add_u32 m0, s39, 52224
    s_add_u32 s22, s36, 55296
    buffer_load_dwordx4 v1, s[72:75], s22 offen sc1 lds
    ds_read_b128 v[200:203], v14 offset:1024
    v_mfma_f32_16x16x32_bf16 v[68:71], a[16:19], v[172:175], v[68:71]
    ds_read_b128 v[204:207], v14 offset:9216
    v_mfma_f32_16x16x32_bf16 v[76:79], a[4:7], v[168:171], 0
    v_mfma_f32_16x16x32_bf16 v[76:79], a[20:23], v[172:175], v[76:79]
    v_mfma_f32_16x16x32_bf16 v[132:135], a[8:11], v[168:171], 0
    v_mfma_f32_16x16x32_bf16 v[132:135], a[24:27], v[172:175], v[132:135]
    s_add_u32 m0, s81, 24832
    s_add_u32 s22, s91, 704512
    buffer_load_dwordx4 v57, s[92:95], s22 offen lds
    v_mfma_f32_16x16x32_bf16 v[140:143], a[12:15], v[168:171], 0
    v_mfma_f32_16x16x32_bf16 v[140:143], a[28:31], v[172:175], v[140:143]
    s_waitcnt lgkmcnt(6)
    v_mfma_f32_16x16x32_bf16 v[80:83], a[0:3], v[176:179], 0
    ds_read_b128 v[208:211], v14 offset:2048
    v_mfma_f32_16x16x32_bf16 v[80:83], a[16:19], v[180:183], v[80:83]
    ds_read_b128 v[212:215], v14 offset:10240
    v_mfma_f32_16x16x32_bf16 v[88:91], a[4:7], v[176:179], 0
    s_add_u32 m0, s81, 25856
    s_add_u32 s22, s91, 704512
    buffer_load_dwordx4 v58, s[92:95], s22 offen lds
    v_mfma_f32_16x16x32_bf16 v[88:91], a[20:23], v[180:183], v[88:91]
    v_mfma_f32_16x16x32_bf16 v[144:147], a[8:11], v[176:179], 0
    v_mfma_f32_16x16x32_bf16 v[144:147], a[24:27], v[180:183], v[144:147]
    v_mfma_f32_16x16x32_bf16 v[152:155], a[12:15], v[176:179], 0
    v_mfma_f32_16x16x32_bf16 v[152:155], a[28:31], v[180:183], v[152:155]
    s_add_u32 m0, s81, 26880
    s_add_u32 s22, s91, 704512
    buffer_load_dwordx4 v59, s[92:95], s22 offen lds
    s_waitcnt lgkmcnt(6)
    v_mfma_f32_16x16x32_bf16 v[84:87], a[0:3], v[184:187], 0
    ds_read_b128 v[216:219], v14 offset:3072
    v_mfma_f32_16x16x32_bf16 v[84:87], a[16:19], v[188:191], v[84:87]
    ds_read_b128 v[220:223], v14 offset:11264
    v_mfma_f32_16x16x32_bf16 v[92:95], a[4:7], v[184:187], 0
    v_mfma_f32_16x16x32_bf16 v[92:95], a[20:23], v[188:191], v[92:95]
    v_mfma_f32_16x16x32_bf16 v[148:151], a[8:11], v[184:187], 0
    s_add_u32 m0, s81, 37248
    s_add_u32 s22, s91, 792576
    buffer_load_dwordx4 v57, s[92:95], s22 offen lds
    v_mfma_f32_16x16x32_bf16 v[148:151], a[24:27], v[188:191], v[148:151]
    v_mfma_f32_16x16x32_bf16 v[156:159], a[12:15], v[184:187], 0
    v_mfma_f32_16x16x32_bf16 v[156:159], a[28:31], v[188:191], v[156:159]
    s_waitcnt lgkmcnt(6)
    v_mfma_f32_16x16x32_bf16 v[96:99], a[0:3], v[192:195], 0
    v_mfma_f32_16x16x32_bf16 v[96:99], a[16:19], v[196:199], v[96:99]
    s_add_u32 m0, s81, 38272
    s_add_u32 s22, s91, 792576
    buffer_load_dwordx4 v58, s[92:95], s22 offen lds
    v_mfma_f32_16x16x32_bf16 v[104:107], a[4:7], v[192:195], 0
    v_mfma_f32_16x16x32_bf16 v[104:107], a[20:23], v[196:199], v[104:107]
    s_waitcnt vmcnt(13)
    s_waitcnt lgkmcnt(0)
    s_barrier
    v_mfma_f32_16x16x32_bf16 v[100:103], a[0:3], v[200:203], 0
    ds_read_b128 v[160:163], v13 offset:16384
    v_mfma_f32_16x16x32_bf16 v[100:103], a[16:19], v[204:207], v[100:103]
    ds_read_b128 v[164:167], v13 offset:24576
    v_mfma_f32_16x16x32_bf16 v[108:111], a[4:7], v[200:203], 0
    s_add_u32 m0, s81, 39296
    s_add_u32 s22, s91, 792576
    buffer_load_dwordx4 v59, s[92:95], s22 offen lds
    ds_read_b128 v[168:171], v13 offset:17408
    v_mfma_f32_16x16x32_bf16 v[108:111], a[20:23], v[204:207], v[108:111]
    ds_read_b128 v[172:175], v13 offset:25600
    v_mfma_f32_16x16x32_bf16 v[112:115], a[0:3], v[208:211], 0
    ds_read_b128 v[176:179], v13 offset:18432
    v_mfma_f32_16x16x32_bf16 v[112:115], a[16:19], v[212:215], v[112:115]
    ds_read_b128 v[180:183], v13 offset:26624
    v_mfma_f32_16x16x32_bf16 v[120:123], a[4:7], v[208:211], 0
    v_mfma_f32_16x16x32_bf16 v[120:123], a[20:23], v[212:215], v[120:123]
    s_add_u32 m0, s39, 0
    s_add_u32 s22, s36, 8192
    buffer_load_dwordx4 v1, s[72:75], s22 offen sc1 lds
    v_mfma_f32_16x16x32_bf16 v[116:119], a[0:3], v[216:219], 0
    ds_read_b128 v[184:187], v13 offset:19456
    v_mfma_f32_16x16x32_bf16 v[116:119], a[16:19], v[220:223], v[116:119]
    ds_read_b128 v[188:191], v13 offset:27648
    v_mfma_f32_16x16x32_bf16 v[124:127], a[4:7], v[216:219], 0
    v_mfma_f32_16x16x32_bf16 v[124:127], a[20:23], v[220:223], v[124:127]
    s_waitcnt lgkmcnt(6)
    v_mfma_f32_16x16x32_bf16 v[64:67], a[32:35], v[160:163], v[64:67]
    s_add_u32 m0, s39, 1024
    s_add_u32 s22, s36, 24576
    buffer_load_dwordx4 v1, s[72:75], s22 offen sc1 lds
    ds_read_b128 v[192:195], v14 offset:16384
    v_mfma_f32_16x16x32_bf16 v[64:67], a[48:51], v[164:167], v[64:67]
    ds_read_b128 v[196:199], v14 offset:24576
    v_mfma_f32_16x16x32_bf16 v[72:75], a[36:39], v[160:163], v[72:75]
    v_mfma_f32_16x16x32_bf16 v[72:75], a[52:55], v[164:167], v[72:75]
    v_mfma_f32_16x16x32_bf16 v[128:131], a[40:43], v[160:163], v[128:131]
    v_mfma_f32_16x16x32_bf16 v[128:131], a[56:59], v[164:167], v[128:131]
    v_mfma_f32_16x16x32_bf16 v[136:139], a[44:47], v[160:163], v[136:139]
    v_mfma_f32_16x16x32_bf16 v[136:139], a[60:63], v[164:167], v[136:139]
    s_waitcnt lgkmcnt(6)
    v_mfma_f32_16x16x32_bf16 v[68:71], a[32:35], v[168:171], v[68:71]
    ds_read_b128 v[200:203], v14 offset:17408
    v_mfma_f32_16x16x32_bf16 v[68:71], a[48:51], v[172:175], v[68:71]
    ds_read_b128 v[204:207], v14 offset:25600
    v_mfma_f32_16x16x32_bf16 v[76:79], a[36:39], v[168:171], v[76:79]
    v_mfma_f32_16x16x32_bf16 v[76:79], a[52:55], v[172:175], v[76:79]
    v_mfma_f32_16x16x32_bf16 v[132:135], a[40:43], v[168:171], v[132:135]
    v_mfma_f32_16x16x32_bf16 v[132:135], a[56:59], v[172:175], v[132:135]
    v_mfma_f32_16x16x32_bf16 v[140:143], a[44:47], v[168:171], v[140:143]
    v_mfma_f32_16x16x32_bf16 v[140:143], a[60:63], v[172:175], v[140:143]
    s_waitcnt lgkmcnt(6)
    v_mfma_f32_16x16x32_bf16 v[80:83], a[32:35], v[176:179], v[80:83]
    ds_read_b128 v[208:211], v14 offset:18432
    v_mfma_f32_16x16x32_bf16 v[80:83], a[48:51], v[180:183], v[80:83]
    s_add_u32 m0, s39, 2048
    s_add_u32 s22, s36, 40960
    buffer_load_dwordx4 v1, s[72:75], s22 offen sc1 lds
    ds_read_b128 v[212:215], v14 offset:26624
    v_mfma_f32_16x16x32_bf16 v[88:91], a[36:39], v[176:179], v[88:91]
    v_mfma_f32_16x16x32_bf16 v[88:91], a[52:55], v[180:183], v[88:91]
    v_mfma_f32_16x16x32_bf16 v[144:147], a[40:43], v[176:179], v[144:147]
    v_mfma_f32_16x16x32_bf16 v[144:147], a[56:59], v[180:183], v[144:147]
    v_mfma_f32_16x16x32_bf16 v[152:155], a[44:47], v[176:179], v[152:155]
    s_add_u32 m0, s39, 3072
    s_add_u32 s22, s36, 57344
    buffer_load_dwordx4 v1, s[72:75], s22 offen sc1 lds
    v_mfma_f32_16x16x32_bf16 v[152:155], a[60:63], v[180:183], v[152:155]
    s_waitcnt lgkmcnt(6)
    v_mfma_f32_16x16x32_bf16 v[84:87], a[32:35], v[184:187], v[84:87]
    ds_read_b128 v[216:219], v14 offset:19456
    v_mfma_f32_16x16x32_bf16 v[84:87], a[48:51], v[188:191], v[84:87]
    ds_read_b128 v[220:223], v14 offset:27648
    v_mfma_f32_16x16x32_bf16 v[92:95], a[36:39], v[184:187], v[92:95]
    v_mfma_f32_16x16x32_bf16 v[92:95], a[52:55], v[188:191], v[92:95]
    s_add_u32 m0, s81, 49664
    s_add_u32 s22, s91, 880640
    buffer_load_dwordx4 v57, s[92:95], s22 offen lds
    v_mfma_f32_16x16x32_bf16 v[148:151], a[40:43], v[184:187], v[148:151]
    v_mfma_f32_16x16x32_bf16 v[148:151], a[56:59], v[188:191], v[148:151]
    v_mfma_f32_16x16x32_bf16 v[156:159], a[44:47], v[184:187], v[156:159]
    v_mfma_f32_16x16x32_bf16 v[156:159], a[60:63], v[188:191], v[156:159]
    s_waitcnt lgkmcnt(6)
    v_mfma_f32_16x16x32_bf16 v[96:99], a[32:35], v[192:195], v[96:99]
    s_add_u32 m0, s81, 50688
    s_add_u32 s22, s91, 880640
    buffer_load_dwordx4 v58, s[92:95], s22 offen lds
    v_mfma_f32_16x16x32_bf16 v[96:99], a[48:51], v[196:199], v[96:99]
    v_mfma_f32_16x16x32_bf16 v[104:107], a[36:39], v[192:195], v[104:107]
    v_mfma_f32_16x16x32_bf16 v[104:107], a[52:55], v[196:199], v[104:107]
    s_waitcnt vmcnt(16)
    s_waitcnt vmcnt(9)
    s_waitcnt lgkmcnt(0)
    s_barrier
    v_mfma_f32_16x16x32_bf16 v[100:103], a[32:35], v[200:203], v[100:103]
    ds_read_b128 v[160:163], v13 offset:32768
    v_mfma_f32_16x16x32_bf16 v[100:103], a[48:51], v[204:207], v[100:103]
    s_add_u32 m0, s81, 51712
    s_add_u32 s22, s91, 880640
    buffer_load_dwordx4 v59, s[92:95], s22 offen lds
    ds_read_b128 v[164:167], v13 offset:40960
    v_mfma_f32_16x16x32_bf16 v[108:111], a[36:39], v[200:203], v[108:111]
    ds_read_b128 v[168:171], v13 offset:33792
    v_mfma_f32_16x16x32_bf16 v[108:111], a[52:55], v[204:207], v[108:111]
    ds_read_b128 v[172:175], v13 offset:41984
    v_mfma_f32_16x16x32_bf16 v[112:115], a[32:35], v[208:211], v[112:115]
    ds_read_b128 v[176:179], v13 offset:34816
    v_mfma_f32_16x16x32_bf16 v[112:115], a[48:51], v[212:215], v[112:115]
    ds_read_b128 v[180:183], v13 offset:43008
    v_mfma_f32_16x16x32_bf16 v[120:123], a[36:39], v[208:211], v[120:123]
    s_add_u32 m0, s81, 62080
    s_add_u32 s22, s91, 968704
    buffer_load_dwordx4 v57, s[92:95], s22 offen lds
    v_mfma_f32_16x16x32_bf16 v[120:123], a[52:55], v[212:215], v[120:123]
    v_mfma_f32_16x16x32_bf16 v[116:119], a[32:35], v[216:219], v[116:119]
    ds_read_b128 v[184:187], v13 offset:35840
    v_mfma_f32_16x16x32_bf16 v[116:119], a[48:51], v[220:223], v[116:119]
    ds_read_b128 v[188:191], v13 offset:44032
    v_mfma_f32_16x16x32_bf16 v[124:127], a[36:39], v[216:219], v[124:127]
    v_mfma_f32_16x16x32_bf16 v[124:127], a[52:55], v[220:223], v[124:127]
    s_add_u32 m0, s81, 63104
    s_add_u32 s22, s91, 968704
    buffer_load_dwordx4 v58, s[92:95], s22 offen lds
    s_waitcnt lgkmcnt(6)
    v_mfma_f32_16x16x32_bf16 v[64:67], a[64:67], v[160:163], v[64:67]
    ds_read_b128 v[192:195], v14 offset:32768
    v_mfma_f32_16x16x32_bf16 v[64:67], a[80:83], v[164:167], v[64:67]
    ds_read_b128 v[196:199], v14 offset:40960
    v_mfma_f32_16x16x32_bf16 v[72:75], a[68:71], v[160:163], v[72:75]
    v_mfma_f32_16x16x32_bf16 v[72:75], a[84:87], v[164:167], v[72:75]
    v_mfma_f32_16x16x32_bf16 v[128:131], a[72:75], v[160:163], v[128:131]
    s_add_u32 m0, s81, 64128
    s_add_u32 s22, s91, 968704
    buffer_load_dwordx4 v59, s[92:95], s22 offen lds
    v_mfma_f32_16x16x32_bf16 v[128:131], a[88:91], v[164:167], v[128:131]
    v_mfma_f32_16x16x32_bf16 v[136:139], a[76:79], v[160:163], v[136:139]
    ds_read_b64_tr_b16 a[128:129], v20 offset:24832
    v_mfma_f32_16x16x32_bf16 v[136:139], a[92:95], v[164:167], v[136:139]
    s_waitcnt lgkmcnt(7)
    v_mfma_f32_16x16x32_bf16 v[68:71], a[64:67], v[168:171], v[68:71]
    ds_read_b128 v[200:203], v14 offset:33792
    v_mfma_f32_16x16x32_bf16 v[68:71], a[80:83], v[172:175], v[68:71]
    s_sub_u32 s22, 0x180, s60
    s_and_b32 s22, s22, 0x380
    s_add_u32 s22, s22, 0
    buffer_load_dword v10, v12, s[60:63], s22 offen
    ds_read_b128 v[204:207], v14 offset:41984
    v_mfma_f32_16x16x32_bf16 v[76:79], a[68:71], v[168:171], v[76:79]
    v_mfma_f32_16x16x32_bf16 v[76:79], a[84:87], v[172:175], v[76:79]
    ds_read_b64_tr_b16 a[130:131], v20 offset:27904
    v_mfma_f32_16x16x32_bf16 v[132:135], a[72:75], v[168:171], v[132:135]
    v_mfma_f32_16x16x32_bf16 v[132:135], a[88:91], v[172:175], v[132:135]
    ds_read_b64_tr_b16 a[132:133], v20 offset:31008
    v_mfma_f32_16x16x32_bf16 v[140:143], a[76:79], v[168:171], v[140:143]
    s_sub_u32 s22, 0x180, s60
    s_and_b32 s22, s22, 0x380
    s_add_u32 s22, s22, 524288
    buffer_load_dword v10, v12, s[60:63], s22 offen
    ds_read_b64_tr_b16 a[134:135], v20 offset:34080
    v_mfma_f32_16x16x32_bf16 v[140:143], a[92:95], v[172:175], v[140:143]
    s_waitcnt lgkmcnt(10)
    v_mfma_f32_16x16x32_bf16 v[80:83], a[64:67], v[176:179], v[80:83]
    ds_read_b128 v[208:211], v14 offset:34816
    v_mfma_f32_16x16x32_bf16 v[80:83], a[80:83], v[180:183], v[80:83]
    ds_read_b128 v[212:215], v14 offset:43008
    v_mfma_f32_16x16x32_bf16 v[88:91], a[68:71], v[176:179], v[88:91]
    v_mfma_f32_16x16x32_bf16 v[88:91], a[84:87], v[180:183], v[88:91]
    s_add_u32 m0, s39, 16384
    s_add_u32 s22, s36, 10240
    buffer_load_dwordx4 v1, s[72:75], s22 offen sc1 lds
    v_mfma_f32_16x16x32_bf16 v[144:147], a[72:75], v[176:179], v[144:147]
    ds_read_b64_tr_b16 a[136:137], v21 offset:24832
    v_mfma_f32_16x16x32_bf16 v[144:147], a[88:91], v[180:183], v[144:147]
    ds_read_b64_tr_b16 a[138:139], v21 offset:27904
    v_mfma_f32_16x16x32_bf16 v[152:155], a[76:79], v[176:179], v[152:155]
    ds_read_b64_tr_b16 a[140:141], v21 offset:31008
    v_mfma_f32_16x16x32_bf16 v[152:155], a[92:95], v[180:183], v[152:155]
    s_waitcnt lgkmcnt(13)
    v_mfma_f32_16x16x32_bf16 v[84:87], a[64:67], v[184:187], v[84:87]
    ds_read_b128 v[216:219], v14 offset:35840
    v_mfma_f32_16x16x32_bf16 v[84:87], a[80:83], v[188:191], v[84:87]
    ds_read_b128 v[220:223], v14 offset:44032
    v_mfma_f32_16x16x32_bf16 v[92:95], a[68:71], v[184:187], v[92:95]
    v_mfma_f32_16x16x32_bf16 v[92:95], a[84:87], v[188:191], v[92:95]
    v_mfma_f32_16x16x32_bf16 v[148:151], a[72:75], v[184:187], v[148:151]
    ds_read_b64_tr_b16 a[142:143], v21 offset:34080
    v_mfma_f32_16x16x32_bf16 v[148:151], a[88:91], v[188:191], v[148:151]
    v_mfma_f32_16x16x32_bf16 v[156:159], a[76:79], v[184:187], v[156:159]
    s_add_u32 m0, s39, 17408
    s_add_u32 s22, s36, 26624
    buffer_load_dwordx4 v1, s[72:75], s22 offen sc1 lds
    v_mfma_f32_16x16x32_bf16 v[156:159], a[92:95], v[188:191], v[156:159]
    s_waitcnt lgkmcnt(14)
    v_mfma_f32_16x16x32_bf16 v[96:99], a[64:67], v[192:195], v[96:99]
    v_mfma_f32_16x16x32_bf16 v[96:99], a[80:83], v[196:199], v[96:99]
    v_mfma_f32_16x16x32_bf16 v[104:107], a[68:71], v[192:195], v[104:107]
    v_mfma_f32_16x16x32_bf16 v[104:107], a[84:87], v[196:199], v[104:107]
    s_add_u32 m0, s39, 18432
    s_add_u32 s22, s36, 43008
    buffer_load_dwordx4 v1, s[72:75], s22 offen sc1 lds
    s_waitcnt vmcnt(15)
    s_waitcnt lgkmcnt(0)
    s_barrier
    v_mfma_f32_16x16x32_bf16 v[100:103], a[64:67], v[200:203], v[100:103]
    ds_read_b128 v[160:163], v13 offset:49152
    v_mfma_f32_16x16x32_bf16 v[100:103], a[80:83], v[204:207], v[100:103]
    ds_read_b128 v[164:167], v13 offset:57344
    v_mfma_f32_16x16x32_bf16 v[108:111], a[68:71], v[200:203], v[108:111]
    ds_read_b128 v[168:171], v13 offset:50176
    v_mfma_f32_16x16x32_bf16 v[108:111], a[84:87], v[204:207], v[108:111]
    ds_read_b128 v[172:175], v13 offset:58368
    v_mfma_f32_16x16x32_bf16 v[112:115], a[64:67], v[208:211], v[112:115]
    s_sub_u32 s22, 0x180, s60
    s_and_b32 s22, s22, 0x380
    s_add_u32 s22, s22, 1048576
    buffer_load_dword v10, v12, s[60:63], s22 offen
    ds_read_b128 v[176:179], v13 offset:51200
    v_mfma_f32_16x16x32_bf16 v[112:115], a[80:83], v[212:215], v[112:115]
    ds_read_b128 v[180:183], v13 offset:59392
    v_mfma_f32_16x16x32_bf16 v[120:123], a[68:71], v[208:211], v[120:123]
    v_mfma_f32_16x16x32_bf16 v[120:123], a[84:87], v[212:215], v[120:123]
    v_mfma_f32_16x16x32_bf16 v[116:119], a[64:67], v[216:219], v[116:119]
    ds_read_b128 v[184:187], v13 offset:52224
    v_mfma_f32_16x16x32_bf16 v[116:119], a[80:83], v[220:223], v[116:119]
    s_add_u32 m0, s39, 19456
    s_add_u32 s22, s36, 59392
    buffer_load_dwordx4 v1, s[72:75], s22 offen sc1 lds
    ds_read_b128 v[188:191], v13 offset:60416
    v_mfma_f32_16x16x32_bf16 v[124:127], a[68:71], v[216:219], v[124:127]
    v_mfma_f32_16x16x32_bf16 v[124:127], a[84:87], v[220:223], v[124:127]
    s_waitcnt lgkmcnt(6)
    v_mfma_f32_16x16x32_bf16 v[64:67], a[96:99], v[160:163], v[64:67]
    ds_read_b128 v[192:195], v14 offset:49152
    v_mfma_f32_16x16x32_bf16 v[64:67], a[112:115], v[164:167], v[64:67]
    ds_read_b128 v[196:199], v14 offset:57344
    v_mfma_f32_16x16x32_bf16 v[72:75], a[100:103], v[160:163], v[72:75]
    s_add_u32 m0, s81, 0
    s_add_u32 s22, s91, 1056768
    buffer_load_dwordx4 v57, s[92:95], s22 offen lds
    v_mfma_f32_16x16x32_bf16 v[72:75], a[116:119], v[164:167], v[72:75]
    v_mfma_f32_16x16x32_bf16 v[128:131], a[104:107], v[160:163], v[128:131]
    v_mfma_f32_16x16x32_bf16 v[128:131], a[120:123], v[164:167], v[128:131]
    v_mfma_f32_16x16x32_bf16 v[136:139], a[108:111], v[160:163], v[136:139]
    ds_read_b64_tr_b16 a[144:145], v22 offset:0
    v_mfma_f32_16x16x32_bf16 v[136:139], a[124:127], v[164:167], v[136:139]
    s_add_u32 m0, s81, 1024
    s_add_u32 s22, s91, 1056768
    buffer_load_dwordx4 v58, s[92:95], s22 offen lds
    s_waitcnt lgkmcnt(7)
    v_mfma_f32_16x16x32_bf16 v[68:71], a[96:99], v[168:171], v[68:71]
    ds_read_b128 v[200:203], v14 offset:50176
    v_mfma_f32_16x16x32_bf16 v[68:71], a[112:115], v[172:175], v[68:71]
    ds_read_b128 v[204:207], v14 offset:58368
    v_mfma_f32_16x16x32_bf16 v[76:79], a[100:103], v[168:171], v[76:79]
    v_mfma_f32_16x16x32_bf16 v[76:79], a[116:119], v[172:175], v[76:79]
    ds_read_b64_tr_b16 a[146:147], v22 offset:3072
    v_mfma_f32_16x16x32_bf16 v[132:135], a[104:107], v[168:171], v[132:135]
    s_add_u32 m0, s81, 2048
    s_add_u32 s22, s91, 1056768
    buffer_load_dwordx4 v59, s[92:95], s22 offen lds
    v_mfma_f32_16x16x32_bf16 v[132:135], a[120:123], v[172:175], v[132:135]
    ds_read_b64_tr_b16 a[148:149], v22 offset:6176
    v_mfma_f32_16x16x32_bf16 v[140:143], a[108:111], v[168:171], v[140:143]
    ds_read_b64_tr_b16 a[150:151], v22 offset:9248
    v_mfma_f32_16x16x32_bf16 v[140:143], a[124:127], v[172:175], v[140:143]
    s_waitcnt lgkmcnt(10)
    v_mfma_f32_16x16x32_bf16 v[80:83], a[96:99], v[176:179], v[80:83]
    ds_read_b128 v[208:211], v14 offset:51200
    v_mfma_f32_16x16x32_bf16 v[80:83], a[112:115], v[180:183], v[80:83]
    s_add_u32 m0, s81, 12416
    s_add_u32 s22, s91, 1144832
    buffer_load_dwordx4 v57, s[92:95], s22 offen lds
    ds_read_b128 v[212:215], v14 offset:59392
    v_mfma_f32_16x16x32_bf16 v[88:91], a[100:103], v[176:179], v[88:91]
    v_mfma_f32_16x16x32_bf16 v[88:91], a[116:119], v[180:183], v[88:91]
    v_mfma_f32_16x16x32_bf16 v[144:147], a[104:107], v[176:179], v[144:147]
    ds_read_b64_tr_b16 a[152:153], v23 offset:0
    v_mfma_f32_16x16x32_bf16 v[144:147], a[120:123], v[180:183], v[144:147]
    ds_read_b64_tr_b16 a[154:155], v23 offset:3072
    v_mfma_f32_16x16x32_bf16 v[152:155], a[108:111], v[176:179], v[152:155]
    ds_read_b64_tr_b16 a[156:157], v23 offset:6176
    v_mfma_f32_16x16x32_bf16 v[152:155], a[124:127], v[180:183], v[152:155]
    s_waitcnt lgkmcnt(13)
    v_mfma_f32_16x16x32_bf16 v[84:87], a[96:99], v[184:187], v[84:87]
    ds_read_b128 v[216:219], v14 offset:52224
    v_mfma_f32_16x16x32_bf16 v[84:87], a[112:115], v[188:191], v[84:87]
    ds_read_b128 v[220:223], v14 offset:60416
    v_mfma_f32_16x16x32_bf16 v[92:95], a[100:103], v[184:187], v[92:95]
    v_mfma_f32_16x16x32_bf16 v[92:95], a[116:119], v[188:191], v[92:95]
    s_add_u32 m0, s81, 13440
    s_add_u32 s22, s91, 1144832
    buffer_load_dwordx4 v58, s[92:95], s22 offen lds
    v_mfma_f32_16x16x32_bf16 v[148:151], a[104:107], v[184:187], v[148:151]
    ds_read_b64_tr_b16 a[158:159], v23 offset:9248
    v_mfma_f32_16x16x32_bf16 v[148:151], a[120:123], v[188:191], v[148:151]
    v_mfma_f32_16x16x32_bf16 v[156:159], a[108:111], v[184:187], v[156:159]
    v_mfma_f32_16x16x32_bf16 v[156:159], a[124:127], v[188:191], v[156:159]
    s_waitcnt lgkmcnt(14)
    v_mfma_f32_16x16x32_bf16 v[96:99], a[96:99], v[192:195], v[96:99]
    s_add_u32 m0, s81, 14464
    s_add_u32 s22, s91, 1144832
    buffer_load_dwordx4 v59, s[92:95], s22 offen lds
    v_mfma_f32_16x16x32_bf16 v[96:99], a[112:115], v[196:199], v[96:99]
    v_mfma_f32_16x16x32_bf16 v[104:107], a[100:103], v[192:195], v[104:107]
    v_mfma_f32_16x16x32_bf16 v[104:107], a[116:119], v[196:199], v[104:107]
    s_waitcnt vmcnt(19)
    s_waitcnt vmcnt(13)
    s_waitcnt lgkmcnt(0)
    s_barrier
    v_mfma_f32_16x16x32_bf16 v[100:103], a[96:99], v[200:203], v[100:103]
    ds_read_b128 v[160:163], v13 offset:0
    v_mfma_f32_16x16x32_bf16 v[100:103], a[112:115], v[204:207], v[100:103]
    s_add_u32 m0, s81, 24832
    s_add_u32 s22, s91, 1232896
    buffer_load_dwordx4 v57, s[92:95], s22 offen lds
    ds_read_b128 v[164:167], v13 offset:8192
    v_mfma_f32_16x16x32_bf16 v[108:111], a[100:103], v[200:203], v[108:111]
    ds_read_b128 v[168:171], v13 offset:1024
    v_mfma_f32_16x16x32_bf16 v[108:111], a[116:119], v[204:207], v[108:111]
    ds_read_b128 v[172:175], v13 offset:9216
    v_mfma_f32_16x16x32_bf16 v[112:115], a[96:99], v[208:211], v[112:115]
    ds_read_b128 v[176:179], v13 offset:2048
    v_mfma_f32_16x16x32_bf16 v[112:115], a[112:115], v[212:215], v[112:115]
    ds_read_b128 v[180:183], v13 offset:10240
    v_mfma_f32_16x16x32_bf16 v[120:123], a[100:103], v[208:211], v[120:123]
    v_mfma_f32_16x16x32_bf16 v[120:123], a[116:119], v[212:215], v[120:123]
    v_mfma_f32_16x16x32_bf16 v[116:119], a[96:99], v[216:219], v[116:119]
    ds_read_b128 v[184:187], v13 offset:3072
    v_mfma_f32_16x16x32_bf16 v[116:119], a[112:115], v[220:223], v[116:119]
    ds_read_b128 v[188:191], v13 offset:11264
    v_mfma_f32_16x16x32_bf16 v[124:127], a[100:103], v[216:219], v[124:127]
    v_mfma_f32_16x16x32_bf16 v[124:127], a[116:119], v[220:223], v[124:127]
    s_waitcnt lgkmcnt(6)
    v_mfma_f32_16x16x32_bf16 v[64:67], a[128:131], v[160:163], v[64:67]
    ds_read_b128 v[192:195], v14 offset:0
    v_mfma_f32_16x16x32_bf16 v[64:67], a[144:147], v[164:167], v[64:67]
    ds_read_b128 v[196:199], v14 offset:8192
    v_mfma_f32_16x16x32_bf16 v[72:75], a[132:135], v[160:163], v[72:75]
    ds_read_b64_tr_b16 a[160:161], v22 offset:12416
    v_mfma_f32_16x16x32_bf16 v[72:75], a[148:151], v[164:167], v[72:75]
    ds_read_b64_tr_b16 a[162:163], v22 offset:15488
    v_mfma_f32_16x16x32_bf16 v[128:131], a[136:139], v[160:163], v[128:131]
    ds_read_b64_tr_b16 a[164:165], v22 offset:18592
    v_mfma_f32_16x16x32_bf16 v[128:131], a[152:155], v[164:167], v[128:131]
    ds_read_b64_tr_b16 a[166:167], v22 offset:21664
    v_mfma_f32_16x16x32_bf16 v[136:139], a[140:143], v[160:163], v[136:139]
    s_add_u32 m0, s81, 25856
    s_add_u32 s22, s91, 1232896
    buffer_load_dwordx4 v58, s[92:95], s22 offen lds
    ds_read_b64_tr_b16 a[168:169], v23 offset:12416
    v_mfma_f32_16x16x32_bf16 v[136:139], a[156:159], v[164:167], v[136:139]
    s_waitcnt lgkmcnt(11)
    v_mfma_f32_16x16x32_bf16 v[68:71], a[128:131], v[168:171], v[68:71]
    ds_read_b128 v[200:203], v14 offset:1024
    v_mfma_f32_16x16x32_bf16 v[68:71], a[144:147], v[172:175], v[68:71]
    ds_read_b128 v[204:207], v14 offset:9216
    v_mfma_f32_16x16x32_bf16 v[76:79], a[132:135], v[168:171], v[76:79]
    v_mfma_f32_16x16x32_bf16 v[76:79], a[148:151], v[172:175], v[76:79]
    s_add_u32 m0, s81, 26880
    s_add_u32 s22, s91, 1232896
    buffer_load_dwordx4 v59, s[92:95], s22 offen lds
    ds_read_b64_tr_b16 a[170:171], v23 offset:15488
    v_mfma_f32_16x16x32_bf16 v[132:135], a[136:139], v[168:171], v[132:135]
    ds_read_b64_tr_b16 a[172:173], v23 offset:18592
    v_mfma_f32_16x16x32_bf16 v[132:135], a[152:155], v[172:175], v[132:135]
    ds_read_b64_tr_b16 a[174:175], v23 offset:21664
    v_mfma_f32_16x16x32_bf16 v[140:143], a[140:143], v[168:171], v[140:143]
    ds_read_b64_tr_b16 a[176:177], v22 offset:24832
    v_mfma_f32_16x16x32_bf16 v[140:143], a[156:159], v[172:175], v[140:143]
    s_waitcnt lgkmcnt(15)
    v_mfma_f32_16x16x32_bf16 v[80:83], a[128:131], v[176:179], v[80:83]
    s_add_u32 m0, s81, 37248
    s_add_u32 s22, s91, 1320960
    buffer_load_dwordx4 v57, s[92:95], s22 offen lds
    ds_read_b128 v[208:211], v14 offset:2048
    v_mfma_f32_16x16x32_bf16 v[80:83], a[144:147], v[180:183], v[80:83]
    ds_read_b128 v[212:215], v14 offset:10240
    v_mfma_f32_16x16x32_bf16 v[88:91], a[132:135], v[176:179], v[88:91]
    ds_read_b64_tr_b16 a[178:179], v22 offset:27904
    v_mfma_f32_16x16x32_bf16 v[88:91], a[148:151], v[180:183], v[88:91]
    ds_read_b64_tr_b16 a[180:181], v22 offset:31008
    v_mfma_f32_16x16x32_bf16 v[144:147], a[136:139], v[176:179], v[144:147]
    ds_read_b64_tr_b16 a[182:183], v22 offset:34080
    v_mfma_f32_16x16x32_bf16 v[144:147], a[152:155], v[180:183], v[144:147]
    s_add_u32 m0, s81, 38272
    s_add_u32 s22, s91, 1320960
    buffer_load_dwordx4 v58, s[92:95], s22 offen lds
    ds_read_b64_tr_b16 a[184:185], v23 offset:24832
    v_mfma_f32_16x16x32_bf16 v[152:155], a[140:143], v[176:179], v[152:155]
    v_mfma_f32_16x16x32_bf16 v[152:155], a[156:159], v[180:183], v[152:155]
    s_waitcnt lgkmcnt(15)
    v_mfma_f32_16x16x32_bf16 v[84:87], a[128:131], v[184:187], v[84:87]
    ds_read_b128 v[216:219], v14 offset:3072
    v_mfma_f32_16x16x32_bf16 v[84:87], a[144:147], v[188:191], v[84:87]
    ds_read_b128 v[220:223], v14 offset:11264
    v_mfma_f32_16x16x32_bf16 v[92:95], a[132:135], v[184:187], v[92:95]
    s_add_u32 m0, s81, 39296
    s_add_u32 s22, s91, 1320960
    buffer_load_dwordx4 v59, s[92:95], s22 offen lds
    ds_read_b64_tr_b16 a[186:187], v23 offset:27904
    v_mfma_f32_16x16x32_bf16 v[92:95], a[148:151], v[188:191], v[92:95]
    ds_read_b64_tr_b16 a[188:189], v23 offset:31008
    v_mfma_f32_16x16x32_bf16 v[148:151], a[136:139], v[184:187], v[148:151]
    ds_read_b64_tr_b16 a[190:191], v23 offset:34080
    v_mfma_f32_16x16x32_bf16 v[148:151], a[152:155], v[188:191], v[148:151]
    v_mfma_f32_16x16x32_bf16 v[156:159], a[140:143], v[184:187], v[156:159]
    v_mfma_f32_16x16x32_bf16 v[156:159], a[156:159], v[188:191], v[156:159]
    s_add_u32 m0, s39, 32768
    s_add_u32 s22, s36, 12288
    buffer_load_dwordx4 v1, s[72:75], s22 offen sc1 lds
    s_waitcnt lgkmcnt(15)
    v_mfma_f32_16x16x32_bf16 v[96:99], a[128:131], v[192:195], v[96:99]
    v_mfma_f32_16x16x32_bf16 v[96:99], a[144:147], v[196:199], v[96:99]
    v_mfma_f32_16x16x32_bf16 v[104:107], a[132:135], v[192:195], v[104:107]
    v_mfma_f32_16x16x32_bf16 v[104:107], a[148:151], v[196:199], v[104:107]
    s_waitcnt vmcnt(13)
    s_waitcnt vmcnt(7)
    s_waitcnt lgkmcnt(0)
    s_barrier
    v_mfma_f32_16x16x32_bf16 v[100:103], a[128:131], v[200:203], v[100:103]
    s_add_u32 m0, s39, 33792
    s_add_u32 s22, s36, 28672
    buffer_load_dwordx4 v1, s[72:75], s22 offen sc1 lds
    ds_read_b128 v[160:163], v13 offset:16384
    v_mfma_f32_16x16x32_bf16 v[100:103], a[144:147], v[204:207], v[100:103]
    ds_read_b128 v[164:167], v13 offset:24576
    v_mfma_f32_16x16x32_bf16 v[108:111], a[132:135], v[200:203], v[108:111]
    ds_read_b128 v[168:171], v13 offset:17408
    v_mfma_f32_16x16x32_bf16 v[108:111], a[148:151], v[204:207], v[108:111]
    ds_read_b128 v[172:175], v13 offset:25600
    v_mfma_f32_16x16x32_bf16 v[112:115], a[128:131], v[208:211], v[112:115]
    ds_read_b128 v[176:179], v13 offset:18432
    v_mfma_f32_16x16x32_bf16 v[112:115], a[144:147], v[212:215], v[112:115]
    s_add_u32 m0, s39, 34816
    s_add_u32 s22, s36, 45056
    buffer_load_dwordx4 v1, s[72:75], s22 offen sc1 lds
    ds_read_b128 v[180:183], v13 offset:26624
    v_mfma_f32_16x16x32_bf16 v[120:123], a[132:135], v[208:211], v[120:123]
    v_mfma_f32_16x16x32_bf16 v[120:123], a[148:151], v[212:215], v[120:123]
    v_mfma_f32_16x16x32_bf16 v[116:119], a[128:131], v[216:219], v[116:119]
    ds_read_b128 v[184:187], v13 offset:19456
    v_mfma_f32_16x16x32_bf16 v[116:119], a[144:147], v[220:223], v[116:119]
    ds_read_b128 v[188:191], v13 offset:27648
    v_mfma_f32_16x16x32_bf16 v[124:127], a[132:135], v[216:219], v[124:127]
    s_add_u32 m0, s39, 35840
    s_add_u32 s22, s36, 61440
    buffer_load_dwordx4 v1, s[72:75], s22 offen sc1 lds
    v_mfma_f32_16x16x32_bf16 v[124:127], a[148:151], v[220:223], v[124:127]
    s_waitcnt lgkmcnt(6)
    v_mfma_f32_16x16x32_bf16 v[64:67], a[160:163], v[160:163], v[64:67]
    ds_read_b128 v[192:195], v14 offset:16384
    v_mfma_f32_16x16x32_bf16 v[64:67], a[176:179], v[164:167], v[64:67]
    ds_read_b128 v[196:199], v14 offset:24576
    v_mfma_f32_16x16x32_bf16 v[72:75], a[164:167], v[160:163], v[72:75]
    ds_read_b64_tr_b16 a[192:193], v20 offset:0
    v_mfma_f32_16x16x32_bf16 v[72:75], a[180:183], v[164:167], v[72:75]
    ds_read_b64_tr_b16 a[194:195], v20 offset:3072
    v_mfma_f32_16x16x32_bf16 v[128:131], a[168:171], v[160:163], v[128:131]
    ds_read_b64_tr_b16 a[196:197], v20 offset:6176
    v_mfma_f32_16x16x32_bf16 v[128:131], a[184:187], v[164:167], v[128:131]
    ds_read_b64_tr_b16 a[198:199], v20 offset:9248
    v_mfma_f32_16x16x32_bf16 v[136:139], a[172:175], v[160:163], v[136:139]
    ds_read_b64_tr_b16 a[200:201], v21 offset:0
    v_mfma_f32_16x16x32_bf16 v[136:139], a[188:191], v[164:167], v[136:139]
    s_waitcnt lgkmcnt(11)
    v_mfma_f32_16x16x32_bf16 v[68:71], a[160:163], v[168:171], v[68:71]
    ds_read_b128 v[200:203], v14 offset:17408
    v_mfma_f32_16x16x32_bf16 v[68:71], a[176:179], v[172:175], v[68:71]
    s_add_u32 m0, s39, 49152
    s_add_u32 s22, s36, 14336
    buffer_load_dwordx4 v1, s[72:75], s22 offen sc1 lds
    ds_read_b128 v[204:207], v14 offset:25600
    v_mfma_f32_16x16x32_bf16 v[76:79], a[164:167], v[168:171], v[76:79]
    v_mfma_f32_16x16x32_bf16 v[76:79], a[180:183], v[172:175], v[76:79]
    ds_read_b64_tr_b16 a[202:203], v21 offset:3072
    v_mfma_f32_16x16x32_bf16 v[132:135], a[168:171], v[168:171], v[132:135]
    ds_read_b64_tr_b16 a[204:205], v21 offset:6176
    v_mfma_f32_16x16x32_bf16 v[132:135], a[184:187], v[172:175], v[132:135]
    ds_read_b64_tr_b16 a[206:207], v21 offset:9248
    v_mfma_f32_16x16x32_bf16 v[140:143], a[172:175], v[168:171], v[140:143]
    s_add_u32 m0, s39, 50176
    s_add_u32 s22, s36, 30720
    buffer_load_dwordx4 v1, s[72:75], s22 offen sc1 lds
    ds_read_b64_tr_b16 a[208:209], v20 offset:12416
    v_mfma_f32_16x16x32_bf16 v[140:143], a[188:191], v[172:175], v[140:143]
    s_waitcnt lgkmcnt(15)
    v_mfma_f32_16x16x32_bf16 v[80:83], a[160:163], v[176:179], v[80:83]
    ds_read_b128 v[208:211], v14 offset:18432
    v_mfma_f32_16x16x32_bf16 v[80:83], a[176:179], v[180:183], v[80:83]
    ds_read_b128 v[212:215], v14 offset:26624
    v_mfma_f32_16x16x32_bf16 v[88:91], a[164:167], v[176:179], v[88:91]
    ds_read_b64_tr_b16 a[210:211], v20 offset:15488
    v_mfma_f32_16x16x32_bf16 v[88:91], a[180:183], v[180:183], v[88:91]
    s_add_u32 m0, s39, 51200
    s_add_u32 s22, s36, 47104
    buffer_load_dwordx4 v1, s[72:75], s22 offen sc1 lds
    ds_read_b64_tr_b16 a[212:213], v20 offset:18592
    v_mfma_f32_16x16x32_bf16 v[144:147], a[168:171], v[176:179], v[144:147]
    ds_read_b64_tr_b16 a[214:215], v20 offset:21664
    v_mfma_f32_16x16x32_bf16 v[144:147], a[184:187], v[180:183], v[144:147]
    ds_read_b64_tr_b16 a[216:217], v21 offset:12416
    v_mfma_f32_16x16x32_bf16 v[152:155], a[172:175], v[176:179], v[152:155]
    v_mfma_f32_16x16x32_bf16 v[152:155], a[188:191], v[180:183], v[152:155]
    s_waitcnt lgkmcnt(15)
    v_mfma_f32_16x16x32_bf16 v[84:87], a[160:163], v[184:187], v[84:87]
    s_add_u32 m0, s39, 52224
    s_add_u32 s22, s36, 63488
    buffer_load_dwordx4 v1, s[72:75], s22 offen sc1 lds
    ds_read_b128 v[216:219], v14 offset:19456
    v_mfma_f32_16x16x32_bf16 v[84:87], a[176:179], v[188:191], v[84:87]
    ds_read_b128 v[220:223], v14 offset:27648
    v_mfma_f32_16x16x32_bf16 v[92:95], a[164:167], v[184:187], v[92:95]
    ds_read_b64_tr_b16 a[218:219], v21 offset:15488
    v_mfma_f32_16x16x32_bf16 v[92:95], a[180:183], v[188:191], v[92:95]
    ds_read_b64_tr_b16 a[220:221], v21 offset:18592
    v_mfma_f32_16x16x32_bf16 v[148:151], a[168:171], v[184:187], v[148:151]
    ds_read_b64_tr_b16 a[222:223], v21 offset:21664
    v_mfma_f32_16x16x32_bf16 v[148:151], a[184:187], v[188:191], v[148:151]
    s_add_u32 m0, s23, 65536
    s_add_u32 s22, s21, 0
    buffer_load_dwordx4 v56, s[60:63], s22 offen lds
    v_mfma_f32_16x16x32_bf16 v[156:159], a[172:175], v[184:187], v[156:159]
    v_mfma_f32_16x16x32_bf16 v[156:159], a[188:191], v[188:191], v[156:159]
    s_waitcnt lgkmcnt(15)
    v_mfma_f32_16x16x32_bf16 v[96:99], a[160:163], v[192:195], v[96:99]
    v_mfma_f32_16x16x32_bf16 v[96:99], a[176:179], v[196:199], v[96:99]
    v_mfma_f32_16x16x32_bf16 v[104:107], a[164:167], v[192:195], v[104:107]
    s_add_u32 m0, s23, 69632
    s_add_u32 s22, s21, 32768
    buffer_load_dwordx4 v56, s[60:63], s22 offen lds
    v_mfma_f32_16x16x32_bf16 v[104:107], a[180:183], v[196:199], v[104:107]
    s_add_u32 m0, s23, 73728
    s_add_u32 s22, s21, 65536
    buffer_load_dwordx4 v56, s[60:63], s22 offen lds
    s_add_u32 m0, s23, 77824
    s_add_u32 s22, s21, 98304
    buffer_load_dwordx4 v56, s[60:63], s22 offen lds
    s_add_u32 m0, s23, 81920
    s_add_u32 s22, s21, 131072
    buffer_load_dwordx4 v56, s[60:63], s22 offen lds
    s_add_u32 m0, s23, 86016
    s_add_u32 s22, s21, 163840
    buffer_load_dwordx4 v56, s[60:63], s22 offen lds
    s_add_u32 m0, s23, 90112
    s_add_u32 s22, s21, 196608
    buffer_load_dwordx4 v56, s[60:63], s22 offen lds
    s_add_u32 m0, s23, 159744
    s_add_u32 s22, s21, 229376
    buffer_load_dwordx4 v56, s[60:63], s22 offen lds
    s_waitcnt vmcnt(8)
    s_waitcnt lgkmcnt(0)
    s_barrier
    v_mfma_f32_16x16x32_bf16 v[100:103], a[160:163], v[200:203], v[100:103]
    ds_read_b128 v[160:163], v13 offset:32768
    ds_read_b64_tr_b16 a[224:225], v20 offset:24832
    ds_read_b64_tr_b16 a[226:227], v20 offset:27904
    v_mfma_f32_16x16x32_bf16 v[100:103], a[176:179], v[204:207], v[100:103]
    s_add_u32 m0, s23, 94208
    s_add_u32 s22, s21, 262144
    buffer_load_dwordx4 v56, s[60:63], s22 offen lds
    ds_read_b128 v[164:167], v13 offset:40960
    ds_read_b64_tr_b16 a[228:229], v20 offset:31008
    v_mfma_f32_16x16x32_bf16 v[108:111], a[164:167], v[200:203], v[108:111]
    ds_read_b128 v[168:171], v13 offset:49152
    ds_read_b64_tr_b16 a[230:231], v20 offset:34080
    v_mfma_f32_16x16x32_bf16 v[108:111], a[180:183], v[204:207], v[108:111]
    ds_read_b128 v[172:175], v13 offset:57344
    ds_read_b64_tr_b16 a[232:233], v21 offset:24832
    ds_read_b64_tr_b16 a[234:235], v21 offset:27904
    v_mfma_f32_16x16x32_bf16 v[112:115], a[160:163], v[208:211], v[112:115]
    ds_read_b128 v[176:179], v13 offset:33792
    ds_read_b64_tr_b16 a[236:237], v21 offset:31008
    v_mfma_f32_16x16x32_bf16 v[112:115], a[176:179], v[212:215], v[112:115]
    ds_read_b128 v[180:183], v13 offset:41984
    ds_read_b64_tr_b16 a[238:239], v21 offset:34080
    v_mfma_f32_16x16x32_bf16 v[120:123], a[164:167], v[208:211], v[120:123]
    s_add_u32 m0, s23, 98304
    s_add_u32 s22, s21, 294912
    buffer_load_dwordx4 v56, s[60:63], s22 offen lds
    ds_read_b64_tr_b16 a[240:241], v22 offset:0
    ds_read_b64_tr_b16 a[242:243], v22 offset:3072
    v_mfma_f32_16x16x32_bf16 v[120:123], a[180:183], v[212:215], v[120:123]
    ds_read_b64_tr_b16 a[244:245], v22 offset:6176
    v_mfma_f32_16x16x32_bf16 v[116:119], a[160:163], v[216:219], v[116:119]
    ds_read_b128 v[184:187], v13 offset:50176
    ds_read_b64_tr_b16 a[246:247], v22 offset:9248
    v_mfma_f32_16x16x32_bf16 v[116:119], a[176:179], v[220:223], v[116:119]
    ds_read_b128 v[188:191], v13 offset:58368
    ds_read_b64_tr_b16 a[248:249], v23 offset:0
    ds_read_b64_tr_b16 a[250:251], v23 offset:3072
    v_mfma_f32_16x16x32_bf16 v[124:127], a[164:167], v[216:219], v[124:127]
    ds_read_b64_tr_b16 a[252:253], v23 offset:6176
    v_mfma_f32_16x16x32_bf16 v[124:127], a[180:183], v[220:223], v[124:127]
    s_add_u32 m0, s23, 102400
    s_add_u32 s22, s21, 327680
    buffer_load_dwordx4 v56, s[60:63], s22 offen lds
    ds_read_b64_tr_b16 a[254:255], v23 offset:9248
    s_waitcnt lgkmcnt(15)
    v_mfma_f32_16x16x32_bf16 v[64:67], a[192:195], v[160:163], v[64:67]
    ds_read_b128 v[192:195], v13 offset:34816
    v_mfma_f32_16x16x32_bf16 v[64:67], a[208:211], v[164:167], v[64:67]
    ds_read_b128 v[196:199], v13 offset:43008
    v_mfma_f32_16x16x32_bf16 v[72:75], a[196:199], v[160:163], v[72:75]
    v_mfma_f32_16x16x32_bf16 v[72:75], a[212:215], v[164:167], v[72:75]
    v_mfma_f32_16x16x32_bf16 v[128:131], a[200:203], v[160:163], v[128:131]
    v_mfma_f32_16x16x32_bf16 v[128:131], a[216:219], v[164:167], v[128:131]
    v_mfma_f32_16x16x32_bf16 v[136:139], a[204:207], v[160:163], v[136:139]
    v_mfma_f32_16x16x32_bf16 v[136:139], a[220:223], v[164:167], v[136:139]
    s_waitcnt lgkmcnt(2)
    v_mfma_f32_16x16x32_bf16 v[64:67], a[224:227], v[168:171], v[64:67]
    ds_read_b128 v[200:203], v13 offset:51200
    v_mfma_f32_16x16x32_bf16 v[64:67], a[240:243], v[172:175], v[64:67]
    ds_read_b128 v[204:207], v13 offset:59392
    v_mfma_f32_16x16x32_bf16 v[72:75], a[228:231], v[168:171], v[72:75]
    v_mfma_f32_16x16x32_bf16 v[72:75], a[244:247], v[172:175], v[72:75]
    v_mfma_f32_16x16x32_bf16 v[128:131], a[232:235], v[168:171], v[128:131]
    v_mfma_f32_16x16x32_bf16 v[128:131], a[248:251], v[172:175], v[128:131]
    s_add_u32 m0, s23, 106496
    s_add_u32 s22, s21, 360448
    buffer_load_dwordx4 v56, s[60:63], s22 offen lds
    v_mfma_f32_16x16x32_bf16 v[136:139], a[236:239], v[168:171], v[136:139]
    v_mfma_f32_16x16x32_bf16 v[136:139], a[252:255], v[172:175], v[136:139]
    v_mfma_f32_16x16x32_bf16 v[68:71], a[192:195], v[176:179], v[68:71]
    ds_read_b128 v[208:211], v13 offset:35840
    v_mfma_f32_16x16x32_bf16 v[68:71], a[208:211], v[180:183], v[68:71]
    ds_read_b128 v[212:215], v13 offset:44032
    v_mfma_f32_16x16x32_bf16 v[76:79], a[196:199], v[176:179], v[76:79]
    s_add_u32 m0, s23, 110592
    s_add_u32 s22, s21, 393216
    buffer_load_dwordx4 v56, s[60:63], s22 offen lds
    v_mfma_f32_16x16x32_bf16 v[76:79], a[212:215], v[180:183], v[76:79]
    v_mfma_f32_16x16x32_bf16 v[132:135], a[200:203], v[176:179], v[132:135]
    v_mfma_f32_16x16x32_bf16 v[132:135], a[216:219], v[180:183], v[132:135]
    v_mfma_f32_16x16x32_bf16 v[140:143], a[204:207], v[176:179], v[140:143]
    v_mfma_f32_16x16x32_bf16 v[140:143], a[220:223], v[180:183], v[140:143]
    s_add_u32 m0, s23, 114688
    s_add_u32 s22, s21, 425984
    buffer_load_dwordx4 v56, s[60:63], s22 offen lds
    v_mfma_f32_16x16x32_bf16 v[68:71], a[224:227], v[184:187], v[68:71]
    ds_read_b128 v[216:219], v13 offset:52224
    v_mfma_f32_16x16x32_bf16 v[68:71], a[240:243], v[188:191], v[68:71]
    ds_read_b128 v[220:223], v13 offset:60416
    v_mfma_f32_16x16x32_bf16 v[76:79], a[228:231], v[184:187], v[76:79]
    v_mfma_f32_16x16x32_bf16 v[76:79], a[244:247], v[188:191], v[76:79]
    v_mfma_f32_16x16x32_bf16 v[132:135], a[232:235], v[184:187], v[132:135]
    s_add_u32 m0, s23, 118784
    s_add_u32 s22, s21, 458752
    buffer_load_dwordx4 v56, s[60:63], s22 offen lds
    v_mfma_f32_16x16x32_bf16 v[132:135], a[248:251], v[188:191], v[132:135]
    v_mfma_f32_16x16x32_bf16 v[140:143], a[236:239], v[184:187], v[140:143]
    v_mfma_f32_16x16x32_bf16 v[140:143], a[252:255], v[188:191], v[140:143]
    s_waitcnt vmcnt(9)
    s_waitcnt lgkmcnt(0)
    s_barrier
    v_mfma_f32_16x16x32_bf16 v[80:83], a[192:195], v[192:195], v[80:83]
    ds_read_b128 v[160:163], v14 offset:32768
    ds_read_b64_tr_b16 a[0:1], v48 offset:0
    v_mfma_f32_16x16x32_bf16 v[80:83], a[208:211], v[196:199], v[80:83]
    s_add_u32 m0, s23, 122880
    s_add_u32 s22, s21, 491520
    buffer_load_dwordx4 v56, s[60:63], s22 offen lds
    ds_read_b128 v[164:167], v14 offset:40960
    v_mfma_f32_16x16x32_bf16 v[88:91], a[196:199], v[192:195], v[88:91]
    ds_read_b64_tr_b16 a[2:3], v48 offset:512
    v_mfma_f32_16x16x32_bf16 v[88:91], a[212:215], v[196:199], v[88:91]
    v_mfma_f32_16x16x32_bf16 v[144:147], a[200:203], v[192:195], v[144:147]
    ds_read_b64_tr_b16 a[4:5], v49 offset:0
    v_mul_f32 v128, s14, v128
    v_mul_f32 v129, s14, v129
    v_mfma_f32_16x16x32_bf16 v[144:147], a[216:219], v[196:199], v[144:147]
    v_mul_f32 v130, s14, v130
    v_mul_f32 v131, s14, v131
    v_mul_f32_e64 v132, s14, v132
    v_mfma_f32_16x16x32_bf16 v[152:155], a[204:207], v[192:195], v[152:155]
    s_add_u32 m0, s23, 12288
    s_add_u32 s22, s21, 524288
    buffer_load_dwordx4 v56, s[60:63], s22 offen lds
    ds_read_b64_tr_b16 a[6:7], v49 offset:512
    v_mul_f32 v133, s14, v133
    v_mul_f32 v134, s14, v134
    v_mfma_f32_16x16x32_bf16 v[152:155], a[220:223], v[196:199], v[152:155]
    v_mul_f32_e64 v135, s14, v135
    v_mfma_f32_16x16x32_bf16 v[80:83], a[224:227], v[200:203], v[80:83]
    ds_read_b128 v[168:171], v14 offset:49152
    ds_read_b64_tr_b16 a[8:9], v50 offset:0
    v_mfma_f32_16x16x32_bf16 v[80:83], a[240:243], v[204:207], v[80:83]
    ds_read_b128 v[172:175], v14 offset:57344
    v_exp_f32_e64 v128, v128
    v_mfma_f32_16x16x32_bf16 v[88:91], a[228:231], v[200:203], v[88:91]
    ds_read_b64_tr_b16 a[10:11], v50 offset:512
    v_exp_f32_e64 v129, v129
    v_mfma_f32_16x16x32_bf16 v[88:91], a[244:247], v[204:207], v[88:91]
    s_add_u32 m0, s23, 16384
    s_add_u32 s22, s21, 557056
    buffer_load_dwordx4 v56, s[60:63], s22 offen lds
    v_exp_f32 v130, v130
    v_exp_f32 v131, v131
    v_mfma_f32_16x16x32_bf16 v[144:147], a[232:235], v[200:203], v[144:147]
    ds_read_b64_tr_b16 a[12:13], v51 offset:0
    v_exp_f32_e64 v132, v132
    v_mfma_f32_16x16x32_bf16 v[144:147], a[248:251], v[204:207], v[144:147]
    v_exp_f32_e64 v133, v133
    v_mfma_f32_16x16x32_bf16 v[152:155], a[236:239], v[200:203], v[152:155]
    ds_read_b64_tr_b16 a[14:15], v51 offset:512
    v_exp_f32_e64 v134, v134
    v_mfma_f32_16x16x32_bf16 v[152:155], a[252:255], v[204:207], v[152:155]
    s_add_u32 m0, s23, 20480
    s_add_u32 s22, s21, 589824
    buffer_load_dwordx4 v56, s[60:63], s22 offen lds
    v_exp_f32 v135, v135
    v_add_f32 v128, 1.0, v128
    v_mfma_f32_16x16x32_bf16 v[84:87], a[192:195], v[208:211], v[84:87]
    ds_read_b128 v[176:179], v14 offset:33792
    ds_read_b64_tr_b16 a[16:17], v48 offset:4096
    v_add_f32_e64 v129, 1.0, v129
    v_mfma_f32_16x16x32_bf16 v[84:87], a[208:211], v[212:215], v[84:87]
    ds_read_b128 v[180:183], v14 offset:41984
    v_add_f32_e64 v130, 1.0, v130
    v_mfma_f32_16x16x32_bf16 v[92:95], a[196:199], v[208:211], v[92:95]
    ds_read_b64_tr_b16 a[18:19], v48 offset:4608
    v_add_f32 v131, 1.0, v131
    v_add_f32 v132, 1.0, v132
    v_mfma_f32_16x16x32_bf16 v[92:95], a[212:215], v[212:215], v[92:95]
    v_add_f32 v133, 1.0, v133
    v_add_f32 v134, 1.0, v134
    v_add_f32_e64 v135, 1.0, v135
    v_mfma_f32_16x16x32_bf16 v[148:151], a[200:203], v[208:211], v[148:151]
    s_add_u32 m0, s23, 24576
    s_add_u32 s22, s21, 622592
    buffer_load_dwordx4 v56, s[60:63], s22 offen lds
    ds_read_b64_tr_b16 a[20:21], v49 offset:4096
    v_rcp_f32_e64 v128, v128
    v_mfma_f32_16x16x32_bf16 v[148:151], a[216:219], v[212:215], v[148:151]
    v_rcp_f32_e64 v129, v129
    v_mfma_f32_16x16x32_bf16 v[156:159], a[204:207], v[208:211], v[156:159]
    ds_read_b64_tr_b16 a[22:23], v49 offset:4608
    v_rcp_f32_e64 v130, v130
    v_mfma_f32_16x16x32_bf16 v[156:159], a[220:223], v[212:215], v[156:159]
    v_rcp_f32_e64 v131, v131
    v_mfma_f32_16x16x32_bf16 v[84:87], a[224:227], v[216:219], v[84:87]
    ds_read_b128 v[184:187], v14 offset:50176
    ds_read_b64_tr_b16 a[24:25], v50 offset:4096
    v_rcp_f32_e64 v132, v132
    s_add_u32 m0, s23, 28672
    s_add_u32 s22, s21, 655360
    buffer_load_dwordx4 v56, s[60:63], s22 offen lds
    v_mfma_f32_16x16x32_bf16 v[84:87], a[240:243], v[220:223], v[84:87]
    ds_read_b128 v[188:191], v14 offset:58368
    v_rcp_f32_e64 v133, v133
    v_mfma_f32_16x16x32_bf16 v[92:95], a[228:231], v[216:219], v[92:95]
    ds_read_b64_tr_b16 a[26:27], v50 offset:4608
    v_rcp_f32_e64 v134, v134
    v_mfma_f32_16x16x32_bf16 v[92:95], a[244:247], v[220:223], v[92:95]
    v_rcp_f32_e64 v135, v135
    v_mfma_f32_16x16x32_bf16 v[148:151], a[232:235], v[216:219], v[148:151]
    ds_read_b64_tr_b16 a[28:29], v51 offset:4096
    v_mul_f32 v128, v128, v136
    v_mul_f32 v129, v129, v137
    v_mfma_f32_16x16x32_bf16 v[148:151], a[248:251], v[220:223], v[148:151]
    s_add_u32 m0, s23, 32768
    s_add_u32 s22, s21, 688128
    buffer_load_dwordx4 v56, s[60:63], s22 offen lds
    v_mul_f32 v130, v130, v138
    v_mul_f32 v131, v131, v139
    v_mul_f32_e64 v132, v132, v140
    v_mfma_f32_16x16x32_bf16 v[156:159], a[236:239], v[216:219], v[156:159]
    ds_read_b64_tr_b16 a[30:31], v51 offset:4608
    v_mul_f32 v133, v133, v141
    v_mul_f32 v134, v134, v142
    v_mfma_f32_16x16x32_bf16 v[156:159], a[252:255], v[220:223], v[156:159]
    v_mul_f32_e64 v135, v135, v143
    v_cvt_pk_bf16_f32 v128, v128, v129
    v_cvt_pk_bf16_f32 v129, v130, v131
    s_waitcnt lgkmcnt(15)
    v_mfma_f32_16x16x32_bf16 v[96:99], a[192:195], v[160:163], v[96:99]
    ds_read_b128 v[192:195], v14 offset:34816
    v_mfma_f32_16x16x32_bf16 v[96:99], a[208:211], v[164:167], v[96:99]
    s_add_u32 m0, s23, 36864
    s_add_u32 s22, s21, 720896
    buffer_load_dwordx4 v56, s[60:63], s22 offen lds
    ds_read_b128 v[196:199], v14 offset:43008
    v_mfma_f32_16x16x32_bf16 v[104:107], a[196:199], v[160:163], v[104:107]
    v_mfma_f32_16x16x32_bf16 v[104:107], a[212:215], v[164:167], v[104:107]
    s_waitcnt lgkmcnt(15)
    v_mfma_f32_16x16x32_bf16 v[96:99], a[224:227], v[168:171], v[96:99]
    ds_read_b128 v[200:203], v14 offset:51200
    v_cvt_pk_bf16_f32 v130, v132, v133
    v_cvt_pk_bf16_f32 v131, v134, v135
    v_mfma_f32_16x16x32_bf16 v[96:99], a[240:243], v[172:175], v[96:99]
    ds_read_b128 v[204:207], v14 offset:59392
    v_permlane16_swap_b32 v128, v130
    v_mfma_f32_16x16x32_bf16 v[104:107], a[228:231], v[168:171], v[104:107]
    s_add_u32 m0, s23, 40960
    s_add_u32 s22, s21, 753664
    buffer_load_dwordx4 v56, s[60:63], s22 offen lds
    v_permlane16_swap_b32 v129, v131
    v_mfma_f32_16x16x32_bf16 v[104:107], a[244:247], v[172:175], v[104:107]
    s_cmp_lt_u32 s89, 3
    s_cbranch_scc1 L_sk_38
    buffer_store_dwordx4 v[128:131], v1, s[72:75], s18 offen sc1
L_sk_38:
    v_mul_f32 v64, s14, v64
    v_mul_f32_e64 v65, s14, v65
    s_waitcnt lgkmcnt(13)
    v_mfma_f32_16x16x32_bf16 v[100:103], a[192:195], v[176:179], v[100:103]
    ds_read_b128 v[208:211], v14 offset:35840
    v_mul_f32 v66, s14, v66
    v_mul_f32 v67, s14, v67
    v_mfma_f32_16x16x32_bf16 v[100:103], a[208:211], v[180:183], v[100:103]
    ds_read_b128 v[212:215], v14 offset:44032
    v_mul_f32 v68, s14, v68
    v_mul_f32 v69, s14, v69
    v_mfma_f32_16x16x32_bf16 v[108:111], a[196:199], v[176:179], v[108:111]
    v_mul_f32 v70, s14, v70
    v_mul_f32 v71, s14, v71
    v_mfma_f32_16x16x32_bf16 v[108:111], a[212:215], v[180:183], v[108:111]
    v_exp_f32 v64, v64
    s_waitcnt lgkmcnt(9)
    v_mfma_f32_16x16x32_bf16 v[100:103], a[224:227], v[184:187], v[100:103]
    s_add_u32 m0, s23, 45056
    s_add_u32 s22, s21, 786432
    buffer_load_dwordx4 v56, s[60:63], s22 offen lds
    ds_read_b128 v[216:219], v14 offset:52224
    v_mfma_f32_16x16x32_bf16 v[100:103], a[240:243], v[188:191], v[100:103]
    ds_read_b128 v[220:223], v14 offset:60416
    v_exp_f32_e64 v65, v65
    v_mfma_f32_16x16x32_bf16 v[108:111], a[228:231], v[184:187], v[108:111]
    v_exp_f32_e64 v66, v66
    v_mfma_f32_16x16x32_bf16 v[108:111], a[244:247], v[188:191], v[108:111]
    v_exp_f32 v67, v67
    v_exp_f32_e64 v68, v68
    s_waitcnt lgkmcnt(6)
    v_mfma_f32_16x16x32_bf16 v[112:115], a[192:195], v[192:195], v[112:115]
    v_mfma_f32_16x16x32_bf16 v[112:115], a[208:211], v[196:199], v[112:115]
    s_add_u32 m0, s23, 49152
    s_add_u32 s22, s21, 819200
    buffer_load_dwordx4 v56, s[60:63], s22 offen lds
    v_mfma_f32_16x16x32_bf16 v[120:123], a[196:199], v[192:195], v[120:123]
    v_mfma_f32_16x16x32_bf16 v[120:123], a[212:215], v[196:199], v[120:123]
    s_waitcnt lgkmcnt(4)
    v_mfma_f32_16x16x32_bf16 v[112:115], a[224:227], v[200:203], v[112:115]
    v_exp_f32 v69, v69
    v_mfma_f32_16x16x32_bf16 v[112:115], a[240:243], v[204:207], v[112:115]
    v_exp_f32_e64 v70, v70
    v_mfma_f32_16x16x32_bf16 v[120:123], a[228:231], v[200:203], v[120:123]
    s_add_u32 m0, s23, 53248
    s_add_u32 s22, s21, 851968
    buffer_load_dwordx4 v56, s[60:63], s22 offen lds
    v_exp_f32 v71, v71
    v_add_f32 v64, 1.0, v64
    v_add_f32_e64 v65, 1.0, v65
    v_mfma_f32_16x16x32_bf16 v[120:123], a[244:247], v[204:207], v[120:123]
    v_add_f32 v66, 1.0, v66
    s_waitcnt lgkmcnt(2)
    v_mfma_f32_16x16x32_bf16 v[116:119], a[192:195], v[208:211], v[116:119]
    v_add_f32 v67, 1.0, v67
    v_add_f32 v68, 1.0, v68
    v_add_f32_e64 v69, 1.0, v69
    v_mfma_f32_16x16x32_bf16 v[116:119], a[208:211], v[212:215], v[116:119]
    v_add_f32 v70, 1.0, v70
    v_add_f32 v71, 1.0, v71
    v_mfma_f32_16x16x32_bf16 v[124:127], a[196:199], v[208:211], v[124:127]
    s_add_u32 m0, s23, 57344
    s_add_u32 s22, s21, 884736
    buffer_load_dwordx4 v56, s[60:63], s22 offen lds
    v_rcp_f32_e64 v64, v64
    v_mfma_f32_16x16x32_bf16 v[124:127], a[212:215], v[212:215], v[124:127]
    v_rcp_f32 v65, v65
    s_waitcnt lgkmcnt(0)
    v_mfma_f32_16x16x32_bf16 v[116:119], a[224:227], v[216:219], v[116:119]
    v_rcp_f32_e64 v66, v66
    v_mfma_f32_16x16x32_bf16 v[116:119], a[240:243], v[220:223], v[116:119]
    v_rcp_f32_e64 v67, v67
    v_mfma_f32_16x16x32_bf16 v[124:127], a[228:231], v[216:219], v[124:127]
    v_rcp_f32 v68, v68
    v_rcp_f32 v69, v69
    s_add_u32 m0, s23, 61440
    s_add_u32 s22, s21, 917504
    buffer_load_dwordx4 v56, s[60:63], s22 offen lds
    v_mfma_f32_16x16x32_bf16 v[124:127], a[244:247], v[220:223], v[124:127]
    v_rcp_f32 v70, v70
    s_waitcnt vmcnt(10)
    s_waitcnt lgkmcnt(0)
    s_barrier
    v_rcp_f32 v71, v71
    v_mul_f32 v64, v64, v72
    v_mul_f32 v65, v65, v73
    v_mul_f32 v66, v66, v74
    v_mul_f32 v67, v67, v75
    v_mul_f32 v68, v68, v76
    v_mul_f32 v69, v69, v77
    v_mul_f32 v70, v70, v78
    v_mul_f32_e64 v71, v71, v79
    v_cvt_pk_bf16_f32 v64, v64, v65
    v_cvt_pk_bf16_f32 v65, v66, v67
    v_cvt_pk_bf16_f32 v66, v68, v69
    v_cvt_pk_bf16_f32 v67, v70, v71
    s_nop 0
    v_permlane16_swap_b32 v64, v66
    v_permlane16_swap_b32 v65, v67
    buffer_store_dwordx4 v[64:67], v1, s[72:75], s98 offen sc1
    v_mul_f32 v144, s14, v144
    v_mul_f32 v145, s14, v145
    v_mul_f32 v146, s14, v146
    v_mul_f32 v147, s14, v147
    v_mul_f32 v148, s14, v148
    v_mul_f32 v149, s14, v149
    v_mul_f32 v150, s14, v150
    v_mul_f32 v151, s14, v151
    v_exp_f32 v144, v144
    v_exp_f32 v145, v145
    v_exp_f32 v146, v146
    v_exp_f32 v147, v147
    v_exp_f32 v148, v148
    v_exp_f32 v149, v149
    v_exp_f32 v150, v150
    v_exp_f32 v151, v151
    v_add_f32 v144, 1.0, v144
    v_add_f32 v145, 1.0, v145
    v_add_f32 v146, 1.0, v146
    v_add_f32 v147, 1.0, v147
    v_add_f32 v148, 1.0, v148
    v_add_f32 v149, 1.0, v149
    v_add_f32 v150, 1.0, v150
    v_add_f32 v151, 1.0, v151
    v_rcp_f32 v144, v144
    v_rcp_f32 v145, v145
    v_rcp_f32 v146, v146
    v_rcp_f32 v147, v147
    v_rcp_f32 v148, v148
    v_rcp_f32 v149, v149
    v_rcp_f32 v150, v150
    v_rcp_f32 v151, v151
    v_mul_f32 v144, v144, v152
    v_mul_f32 v145, v145, v153
    v_mul_f32 v146, v146, v154
    v_mul_f32 v147, v147, v155
    v_mul_f32 v148, v148, v156
    v_mul_f32 v149, v149, v157
    v_mul_f32 v150, v150, v158
    v_mul_f32_e64 v151, v151, v159
    v_cvt_pk_bf16_f32 v144, v144, v145
    v_cvt_pk_bf16_f32 v145, v146, v147
    v_cvt_pk_bf16_f32 v146, v148, v149
    v_cvt_pk_bf16_f32 v147, v150, v151
    s_nop 0
    v_permlane16_swap_b32 v144, v146
    v_permlane16_swap_b32 v145, v147
    s_cmp_lt_u32 s89, 3
    s_cbranch_scc1 L_sk_39
    buffer_store_dwordx4 v[144:147], v1, s[72:75], s19 offen sc1
L_sk_39:
    v_mul_f32 v80, s14, v80
    v_mul_f32 v81, s14, v81
    v_mul_f32 v82, s14, v82
    v_mul_f32 v83, s14, v83
    v_mul_f32 v84, s14, v84
    v_mul_f32 v85, s14, v85
    v_mul_f32 v86, s14, v86
    v_mul_f32 v87, s14, v87
    v_exp_f32 v80, v80
    v_exp_f32 v81, v81
    v_exp_f32 v82, v82
    v_exp_f32 v83, v83
    v_exp_f32 v84, v84
    v_exp_f32 v85, v85
    v_exp_f32 v86, v86
    v_exp_f32 v87, v87
    v_add_f32 v80, 1.0, v80
    v_add_f32 v81, 1.0, v81
    v_add_f32 v82, 1.0, v82
    v_add_f32 v83, 1.0, v83
    v_add_f32 v84, 1.0, v84
    v_add_f32 v85, 1.0, v85
    v_add_f32 v86, 1.0, v86
    v_add_f32 v87, 1.0, v87
    v_rcp_f32 v80, v80
    v_rcp_f32 v81, v81
    v_rcp_f32 v82, v82
    v_rcp_f32 v83, v83
    v_rcp_f32 v84, v84
    v_rcp_f32 v85, v85
    v_rcp_f32 v86, v86
    v_rcp_f32 v87, v87
    v_mul_f32 v80, v80, v88
    v_mul_f32 v81, v81, v89
    v_mul_f32 v82, v82, v90
    v_mul_f32 v83, v83, v91
    v_mul_f32 v84, v84, v92
    v_mul_f32 v85, v85, v93
    v_mul_f32 v86, v86, v94
    v_mul_f32_e64 v87, v87, v95
    v_cvt_pk_bf16_f32 v80, v80, v81
    v_cvt_pk_bf16_f32 v81, v82, v83
    v_cvt_pk_bf16_f32 v82, v84, v85
    v_cvt_pk_bf16_f32 v83, v86, v87
    s_nop 0
    v_permlane16_swap_b32 v80, v82
    v_permlane16_swap_b32 v81, v83
    buffer_store_dwordx4 v[80:83], v1, s[72:75], s16 offen sc1
    v_mul_f32 v96, s14, v96
    v_mul_f32 v97, s14, v97
    v_mul_f32 v98, s14, v98
    v_mul_f32 v99, s14, v99
    v_mul_f32 v100, s14, v100
    v_mul_f32 v101, s14, v101
    v_mul_f32 v102, s14, v102
    v_mul_f32 v103, s14, v103
    v_exp_f32 v96, v96
    v_exp_f32 v97, v97
    v_exp_f32 v98, v98
    v_exp_f32 v99, v99
    v_exp_f32 v100, v100
    v_exp_f32 v101, v101
    v_exp_f32 v102, v102
    v_exp_f32 v103, v103
    v_add_f32 v96, 1.0, v96
    v_add_f32 v97, 1.0, v97
    v_add_f32 v98, 1.0, v98
    v_add_f32 v99, 1.0, v99
    v_add_f32 v100, 1.0, v100
    v_add_f32 v101, 1.0, v101
    v_add_f32 v102, 1.0, v102
    v_add_f32 v103, 1.0, v103
    v_rcp_f32 v96, v96
    v_rcp_f32 v97, v97
    v_rcp_f32 v98, v98
    v_rcp_f32 v99, v99
    v_rcp_f32 v100, v100
    v_rcp_f32 v101, v101
    v_rcp_f32 v102, v102
    v_rcp_f32 v103, v103
    v_mul_f32 v96, v96, v104
    v_mul_f32 v97, v97, v105
    v_mul_f32 v98, v98, v106
    v_mul_f32 v99, v99, v107
    v_mul_f32 v100, v100, v108
    v_mul_f32 v101, v101, v109
    v_mul_f32 v102, v102, v110
    v_mul_f32_e64 v103, v103, v111
    v_cvt_pk_bf16_f32 v96, v96, v97
    v_cvt_pk_bf16_f32 v97, v98, v99
    v_cvt_pk_bf16_f32 v98, v100, v101
    v_cvt_pk_bf16_f32 v99, v102, v103
    s_nop 0
    v_permlane16_swap_b32 v96, v98
    v_permlane16_swap_b32 v97, v99
    buffer_store_dwordx4 v[96:99], v1, s[72:75], s83 offen sc1
    v_pk_mul_f32 v[112:113], v[112:113], s[14:15] op_sel_hi:[1,0]
    v_pk_mul_f32 v[114:115], v[114:115], s[14:15] op_sel_hi:[1,0]
    v_pk_mul_f32 v[116:117], v[116:117], s[14:15] op_sel_hi:[1,0]
    v_pk_mul_f32 v[118:119], v[118:119], s[14:15] op_sel_hi:[1,0]
    v_exp_f32 v112, v112
    v_exp_f32 v113, v113
    v_exp_f32 v114, v114
    v_exp_f32 v115, v115
    v_exp_f32 v116, v116
    v_exp_f32 v117, v117
    v_exp_f32 v118, v118
    v_exp_f32_e64 v119, v119
    v_pk_add_f32 v[112:113], v[112:113], 1.0 op_sel_hi:[1,0]
    v_pk_add_f32 v[114:115], v[114:115], 1.0 op_sel_hi:[1,0]
    v_pk_add_f32 v[116:117], v[116:117], 1.0 op_sel_hi:[1,0]
    v_pk_add_f32 v[118:119], v[118:119], 1.0 op_sel_hi:[1,0]
    v_rcp_f32 v112, v112
    v_rcp_f32 v113, v113
    v_rcp_f32 v114, v114
    v_rcp_f32 v115, v115
    v_rcp_f32 v116, v116
    v_rcp_f32 v117, v117
    v_rcp_f32 v118, v118
    v_rcp_f32 v119, v119
    v_pk_mul_f32 v[112:113], v[112:113], v[120:121]
    v_pk_mul_f32 v[114:115], v[114:115], v[122:123]
    v_pk_mul_f32 v[116:117], v[116:117], v[124:125]
    v_pk_mul_f32 v[118:119], v[118:119], v[126:127]
    v_cvt_pk_bf16_f32 v112, v112, v113
    v_cvt_pk_bf16_f32 v113, v114, v115
    v_cvt_pk_bf16_f32 v114, v116, v117
    v_cvt_pk_bf16_f32 v115, v118, v119
    s_nop 0
    v_permlane16_swap_b32 v112, v114
    v_permlane16_swap_b32 v113, v115
    buffer_store_dwordx4 v[112:115], v1, s[72:75], s17 offen sc1
    s_add_u32 m0, s23, 126976
    s_add_u32 s22, s21, 950272
    buffer_load_dwordx4 v56, s[60:63], s22 offen lds
    s_add_u32 m0, s23, 131072
    s_add_u32 s22, s21, 983040
    buffer_load_dwordx4 v56, s[60:63], s22 offen lds
    s_add_u32 m0, s23, 135168
    s_add_u32 s22, s21, 1015808
    buffer_load_dwordx4 v56, s[60:63], s22 offen lds
    s_add_u32 m0, s23, 139264
    s_add_u32 s22, s21, 1048576
    buffer_load_dwordx4 v56, s[60:63], s22 offen lds
    s_add_u32 m0, s23, 143360
    s_add_u32 s22, s21, 1081344
    buffer_load_dwordx4 v56, s[60:63], s22 offen lds
    s_add_u32 m0, s23, 147456
    s_add_u32 s22, s21, 1114112
    buffer_load_dwordx4 v56, s[60:63], s22 offen lds
    s_add_u32 m0, s23, 151552
    s_add_u32 s22, s21, 1146880
    buffer_load_dwordx4 v56, s[60:63], s22 offen lds
    s_add_u32 m0, s23, 155648
    s_add_u32 s22, s21, 1179648
    buffer_load_dwordx4 v56, s[60:63], s22 offen lds
    v_lshrrev_b32 v11, 1, v2
    v_lshlrev_b32 v11, 10, v11
    v_and_b32 v5, 1, v2
    v_lshl_add_u32 v11, v5, 9, v11
    v_lshl_add_u32 v11, v3, 4, v11
    ds_read_b64_tr_b16 a[32:33], v48 offset:8192
    ds_read_b64_tr_b16 a[34:35], v48 offset:8704
    ds_read_b64_tr_b16 a[36:37], v49 offset:8192
    ds_read_b64_tr_b16 a[38:39], v49 offset:8704
    ds_read_b64_tr_b16 a[40:41], v50 offset:8192
    ds_read_b64_tr_b16 a[42:43], v50 offset:8704
    ds_read_b64_tr_b16 a[44:45], v51 offset:8192
    ds_read_b64_tr_b16 a[46:47], v51 offset:8704
    ds_read_b64_tr_b16 a[48:49], v48 offset:12288
    ds_read_b64_tr_b16 a[50:51], v48 offset:12800
    ds_read_b64_tr_b16 a[52:53], v49 offset:12288
    ds_read_b64_tr_b16 a[54:55], v49 offset:12800
    ds_read_b64_tr_b16 a[56:57], v50 offset:12288
    ds_read_b64_tr_b16 a[58:59], v50 offset:12800
    ds_read_b64_tr_b16 a[60:61], v51 offset:12288
    ds_read_b64_tr_b16 a[62:63], v51 offset:12800
    ds_read_b64_tr_b16 a[64:65], v48 offset:16384
    ds_read_b64_tr_b16 a[66:67], v48 offset:16896
    ds_read_b64_tr_b16 a[68:69], v49 offset:16384
    ds_read_b64_tr_b16 a[70:71], v49 offset:16896
    ds_read_b64_tr_b16 a[72:73], v50 offset:16384
    ds_read_b64_tr_b16 a[74:75], v50 offset:16896
    ds_read_b64_tr_b16 a[76:77], v51 offset:16384
    ds_read_b64_tr_b16 a[78:79], v51 offset:16896
    ds_read_b64_tr_b16 a[80:81], v48 offset:20480
    ds_read_b64_tr_b16 a[82:83], v48 offset:20992
    ds_read_b64_tr_b16 a[84:85], v49 offset:20480
    ds_read_b64_tr_b16 a[86:87], v49 offset:20992
    ds_read_b64_tr_b16 a[88:89], v50 offset:20480
    ds_read_b64_tr_b16 a[90:91], v50 offset:20992
    ds_read_b64_tr_b16 a[92:93], v51 offset:20480
    ds_read_b64_tr_b16 a[94:95], v51 offset:20992
    ds_read_b64_tr_b16 a[96:97], v48 offset:24576
    ds_read_b64_tr_b16 a[98:99], v48 offset:25088
    ds_read_b64_tr_b16 a[100:101], v49 offset:24576
    ds_read_b64_tr_b16 a[102:103], v49 offset:25088
    ds_read_b64_tr_b16 a[104:105], v50 offset:24576
    ds_read_b64_tr_b16 a[106:107], v50 offset:25088
    ds_read_b64_tr_b16 a[108:109], v51 offset:24576
    ds_read_b64_tr_b16 a[110:111], v51 offset:25088
    s_waitcnt lgkmcnt(0)
    s_add_u32 s12, s80, s84
    v_mov_b32 v5, s8
    v_lshlrev_b32_e64 v9, 2, v3
    s_waitcnt vmcnt(8)
    s_barrier
    s_cmp_lg_u32 s4, 0
    s_cbranch_scc1 L_pf_41
    s_mov_b64 exec, 1
    s_cmp_lg_u32 s9, 0
    s_cbranch_scc1 L_pf_40
    buffer_store_dword v5, off, s[72:75], s12 offset:192 sc1
    s_mov_b64 exec, -1
    s_branch L_pf_41
L_pf_40:
    buffer_store_dword v5, off, s[72:75], s12 offset:192
    s_mov_b64 exec, -1
L_pf_41:
    buffer_load_dword v8, v9, s[72:75], s84 offen offset:192 sc1
    s_add_u32 m0, s23, 65536
    s_add_u32 s22, s21, 1212416
    buffer_load_dwordx4 v56, s[60:63], s22 offen lds
    s_add_u32 m0, s23, 69632
    s_add_u32 s22, s21, 1245184
    buffer_load_dwordx4 v56, s[60:63], s22 offen lds
    s_add_u32 m0, s23, 73728
    s_add_u32 s22, s21, 1277952
    buffer_load_dwordx4 v56, s[60:63], s22 offen lds
    s_add_u32 m0, s23, 77824
    s_add_u32 s22, s21, 1310720
    buffer_load_dwordx4 v56, s[60:63], s22 offen lds
    s_add_u32 m0, s23, 81920
    s_add_u32 s22, s21, 1343488
    buffer_load_dwordx4 v56, s[60:63], s22 offen lds
    s_add_u32 m0, s23, 86016
    s_add_u32 s22, s21, 1376256
    buffer_load_dwordx4 v56, s[60:63], s22 offen lds
    ds_read_b64_tr_b16 a[112:113], v52 offset:28672
    ds_read_b64_tr_b16 a[114:115], v52 offset:29184
    ds_read_b64_tr_b16 a[116:117], v53 offset:28672
    ds_read_b64_tr_b16 a[118:119], v53 offset:29184
    ds_read_b64_tr_b16 a[120:121], v54 offset:28672
    ds_read_b64_tr_b16 a[122:123], v54 offset:29184
    ds_read_b64_tr_b16 a[124:125], v55 offset:28672
    ds_read_b64_tr_b16 a[126:127], v55 offset:29184
    ds_read_b64_tr_b16 a[128:129], v48 offset:28672
    ds_read_b64_tr_b16 a[130:131], v48 offset:29184
    ds_read_b64_tr_b16 a[132:133], v49 offset:28672
    ds_read_b64_tr_b16 a[134:135], v49 offset:29184
    ds_read_b64_tr_b16 a[136:137], v50 offset:28672
    ds_read_b64_tr_b16 a[138:139], v50 offset:29184
    ds_read_b64_tr_b16 a[140:141], v51 offset:28672
    ds_read_b64_tr_b16 a[142:143], v51 offset:29184
    ds_read_b64_tr_b16 a[144:145], v48 offset:32768
    ds_read_b64_tr_b16 a[146:147], v48 offset:33280
    ds_read_b64_tr_b16 a[148:149], v49 offset:32768
    ds_read_b64_tr_b16 a[150:151], v49 offset:33280
    ds_read_b64_tr_b16 a[152:153], v50 offset:32768
    ds_read_b64_tr_b16 a[154:155], v50 offset:33280
    ds_read_b64_tr_b16 a[156:157], v51 offset:32768
    ds_read_b64_tr_b16 a[158:159], v51 offset:33280
    ds_read_b64_tr_b16 a[160:161], v48 offset:36864
    ds_read_b64_tr_b16 a[162:163], v48 offset:37376
    ds_read_b64_tr_b16 a[164:165], v49 offset:36864
    ds_read_b64_tr_b16 a[166:167], v49 offset:37376
    ds_read_b64_tr_b16 a[168:169], v50 offset:36864
    ds_read_b64_tr_b16 a[170:171], v50 offset:37376
    ds_read_b64_tr_b16 a[172:173], v51 offset:36864
    ds_read_b64_tr_b16 a[174:175], v51 offset:37376
    ds_read_b64_tr_b16 a[176:177], v48 offset:40960
    ds_read_b64_tr_b16 a[178:179], v48 offset:41472
    ds_read_b64_tr_b16 a[180:181], v49 offset:40960
    ds_read_b64_tr_b16 a[182:183], v49 offset:41472
    ds_read_b64_tr_b16 a[184:185], v50 offset:40960
    ds_read_b64_tr_b16 a[186:187], v50 offset:41472
    ds_read_b64_tr_b16 a[188:189], v51 offset:40960
    ds_read_b64_tr_b16 a[190:191], v51 offset:41472
    s_waitcnt vmcnt(6)
    s_branch L_c_42
L_p_43:
    buffer_load_dword v8, v9, s[72:75], s84 offen offset:192 sc1
    s_waitcnt vmcnt(0)
L_c_42:
    v_cmp_ne_u32_e64 vcc, s8, v8
    s_nop 1
    s_cbranch_vccz L_d_44
    s_sub_u32 s87, s87, 1
    s_cmp_eq_u32 s87, 0
    s_cbranch_scc1 L_giveup
    s_branch L_p_43
L_d_44:
    ds_read_b64_tr_b16 a[192:193], v48 offset:45056
    s_add_u32 s28, s38, 0
    buffer_load_dwordx4 v[80:83], v11, s[72:75], s28 offen offset:0 sc1
    ds_read_b64_tr_b16 a[194:195], v48 offset:45568
    ds_read_b64_tr_b16 a[196:197], v49 offset:45056
    ds_read_b64_tr_b16 a[198:199], v49 offset:45568
    ds_read_b64_tr_b16 a[200:201], v50 offset:45056
    ds_read_b64_tr_b16 a[202:203], v50 offset:45568
    ds_read_b64_tr_b16 a[204:205], v51 offset:45056
    buffer_load_dwordx4 v[84:87], v11, s[72:75], s28 offen offset:2048 sc1
    ds_read_b64_tr_b16 a[206:207], v51 offset:45568
    ds_read_b64_tr_b16 a[208:209], v48 offset:49152
    ds_read_b64_tr_b16 a[210:211], v48 offset:49664
    ds_read_b64_tr_b16 a[212:213], v49 offset:49152
    ds_read_b64_tr_b16 a[214:215], v49 offset:49664
    ds_read_b64_tr_b16 a[216:217], v50 offset:49152
    s_add_u32 s28, s38, 4096
    buffer_load_dwordx4 v[88:91], v11, s[72:75], s28 offen offset:0 sc1
    ds_read_b64_tr_b16 a[218:219], v50 offset:49664
    ds_read_b64_tr_b16 a[220:221], v51 offset:49152
    ds_read_b64_tr_b16 a[222:223], v51 offset:49664
    ds_read_b64_tr_b16 a[224:225], v48 offset:53248
    ds_read_b64_tr_b16 a[226:227], v48 offset:53760
    ds_read_b64_tr_b16 a[228:229], v49 offset:53248
    buffer_load_dwordx4 v[92:95], v11, s[72:75], s28 offen offset:2048 sc1
    ds_read_b64_tr_b16 a[230:231], v49 offset:53760
    ds_read_b64_tr_b16 a[232:233], v50 offset:53248
    ds_read_b64_tr_b16 a[234:235], v50 offset:53760
    ds_read_b64_tr_b16 a[236:237], v51 offset:53248
    ds_read_b64_tr_b16 a[238:239], v51 offset:53760
    ds_read_b64_tr_b16 a[240:241], v48 offset:57344
    s_add_u32 s28, s38, 8192
    buffer_load_dwordx4 v[96:99], v11, s[72:75], s28 offen offset:0 sc1
    ds_read_b64_tr_b16 a[242:243], v48 offset:57856
    ds_read_b64_tr_b16 a[244:245], v49 offset:57344
    ds_read_b64_tr_b16 a[246:247], v49 offset:57856
    ds_read_b64_tr_b16 a[248:249], v50 offset:57344
    ds_read_b64_tr_b16 a[250:251], v50 offset:57856
    ds_read_b64_tr_b16 a[252:253], v51 offset:57344
    buffer_load_dwordx4 v[100:103], v11, s[72:75], s28 offen offset:2048 sc1
    ds_read_b64_tr_b16 a[254:255], v51 offset:57856
    ds_read_b64_tr_b16 v[144:145], v16 offset:12288
    ds_read_b64_tr_b16 v[146:147], v16 offset:12800
    ds_read_b64_tr_b16 v[148:149], v17 offset:12288
    ds_read_b64_tr_b16 v[150:151], v17 offset:12800
    ds_read_b64_tr_b16 v[152:153], v18 offset:12288
    s_add_u32 s28, s38, 12288
    buffer_load_dwordx4 v[104:107], v11, s[72:75], s28 offen offset:0 sc1
    ds_read_b64_tr_b16 v[154:155], v18 offset:12800
    ds_read_b64_tr_b16 v[156:157], v19 offset:12288
    ds_read_b64_tr_b16 v[158:159], v19 offset:12800
    ds_read_b64_tr_b16 v[160:161], v16 offset:16384
    ds_read_b64_tr_b16 v[162:163], v16 offset:16896
    ds_read_b64_tr_b16 v[164:165], v17 offset:16384
    buffer_load_dwordx4 v[108:111], v11, s[72:75], s28 offen offset:2048 sc1
    ds_read_b64_tr_b16 v[166:167], v17 offset:16896
    ds_read_b64_tr_b16 v[168:169], v18 offset:16384
    ds_read_b64_tr_b16 v[170:171], v18 offset:16896
    ds_read_b64_tr_b16 v[172:173], v19 offset:16384
    ds_read_b64_tr_b16 v[174:175], v19 offset:16896
    ds_read_b64_tr_b16 v[176:177], v16 offset:20480
    s_add_u32 s28, s38, 16384
    buffer_load_dwordx4 v[112:115], v11, s[72:75], s28 offen offset:0 sc1
    ds_read_b64_tr_b16 v[178:179], v16 offset:20992
    ds_read_b64_tr_b16 v[180:181], v17 offset:20480
    ds_read_b64_tr_b16 v[182:183], v17 offset:20992
    ds_read_b64_tr_b16 v[184:185], v18 offset:20480
    ds_read_b64_tr_b16 v[186:187], v18 offset:20992
    ds_read_b64_tr_b16 v[188:189], v19 offset:20480
    buffer_load_dwordx4 v[116:119], v11, s[72:75], s28 offen offset:2048 sc1
    ds_read_b64_tr_b16 v[190:191], v19 offset:20992
    ds_read_b64_tr_b16 v[192:193], v16 offset:24576
    ds_read_b64_tr_b16 v[194:195], v16 offset:25088
    ds_read_b64_tr_b16 v[196:197], v17 offset:24576
    ds_read_b64_tr_b16 v[198:199], v17 offset:25088
    ds_read_b64_tr_b16 v[200:201], v18 offset:24576
    s_add_u32 s28, s38, 20480
    buffer_load_dwordx4 v[120:123], v11, s[72:75], s28 offen offset:0 sc1
    ds_read_b64_tr_b16 v[202:203], v18 offset:25088
    ds_read_b64_tr_b16 v[204:205], v19 offset:24576
    ds_read_b64_tr_b16 v[206:207], v19 offset:25088
    ds_read_b64_tr_b16 v[208:209], v16 offset:28672
    ds_read_b64_tr_b16 v[210:211], v16 offset:29184
    ds_read_b64_tr_b16 v[212:213], v17 offset:28672
    buffer_load_dwordx4 v[124:127], v11, s[72:75], s28 offen offset:2048 sc1
    ds_read_b64_tr_b16 v[214:215], v17 offset:29184
    ds_read_b64_tr_b16 v[216:217], v18 offset:28672
    ds_read_b64_tr_b16 v[218:219], v18 offset:29184
    ds_read_b64_tr_b16 v[220:221], v19 offset:28672
    ds_read_b64_tr_b16 v[222:223], v19 offset:29184
    ds_read_b64_tr_b16 v[224:225], v16 offset:32768
    ds_read_b64_tr_b16 v[226:227], v16 offset:33280
    ds_read_b64_tr_b16 v[228:229], v17 offset:32768
    ds_read_b64_tr_b16 v[230:231], v17 offset:33280
    ds_read_b64_tr_b16 v[232:233], v18 offset:32768
    ds_read_b64_tr_b16 v[234:235], v18 offset:33280
    ds_read_b64_tr_b16 v[236:237], v19 offset:32768
    ds_read_b64_tr_b16 v[238:239], v19 offset:33280
    ds_read_b64_tr_b16 v[240:241], v16 offset:36864
    ds_read_b64_tr_b16 v[242:243], v16 offset:37376
    ds_read_b64_tr_b16 v[244:245], v17 offset:36864
    ds_read_b64_tr_b16 v[246:247], v17 offset:37376
    ds_read_b64_tr_b16 v[248:249], v18 offset:36864
    ds_read_b64_tr_b16 v[250:251], v18 offset:37376
    ds_read_b64_tr_b16 v[252:253], v19 offset:36864
    ds_read_b64_tr_b16 v[254:255], v19 offset:37376
    s_waitcnt vmcnt(11)
    v_mfma_f32_16x16x32_bf16 v[64:67], a[0:3], v[80:83], 0
    s_add_u32 s28, s38, 24576
    buffer_load_dwordx4 v[128:131], v11, s[72:75], s28 offen offset:0 sc1
    ds_read_b64_tr_b16 a[0:1], v16 offset:40960
    ds_read_b64_tr_b16 a[2:3], v16 offset:41472
    v_mfma_f32_16x16x32_bf16 v[68:71], a[4:7], v[80:83], 0
    ds_read_b64_tr_b16 a[4:5], v17 offset:40960
    ds_read_b64_tr_b16 a[6:7], v17 offset:41472
    v_mfma_f32_16x16x32_bf16 v[72:75], a[8:11], v[80:83], 0
    ds_read_b64_tr_b16 a[8:9], v18 offset:40960
    ds_read_b64_tr_b16 a[10:11], v18 offset:41472
    v_mfma_f32_16x16x32_bf16 v[76:79], a[12:15], v[80:83], 0
    ds_read_b64_tr_b16 a[12:13], v19 offset:40960
    ds_read_b64_tr_b16 a[14:15], v19 offset:41472
    s_waitcnt vmcnt(11)
    v_mfma_f32_16x16x32_bf16 v[64:67], a[16:19], v[84:87], v[64:67]
    buffer_load_dwordx4 v[132:135], v11, s[72:75], s28 offen offset:2048 sc1
    ds_read_b64_tr_b16 a[16:17], v16 offset:45056
    ds_read_b64_tr_b16 a[18:19], v16 offset:45568
    v_mfma_f32_16x16x32_bf16 v[68:71], a[20:23], v[84:87], v[68:71]
    ds_read_b64_tr_b16 a[20:21], v17 offset:45056
    ds_read_b64_tr_b16 a[22:23], v17 offset:45568
    v_mfma_f32_16x16x32_bf16 v[72:75], a[24:27], v[84:87], v[72:75]
    ds_read_b64_tr_b16 a[24:25], v18 offset:45056
    ds_read_b64_tr_b16 a[26:27], v18 offset:45568
    v_mfma_f32_16x16x32_bf16 v[76:79], a[28:31], v[84:87], v[76:79]
    ds_read_b64_tr_b16 a[28:29], v19 offset:45056
    ds_read_b64_tr_b16 a[30:31], v19 offset:45568
    s_waitcnt vmcnt(11)
    v_mfma_f32_16x16x32_bf16 v[64:67], a[32:35], v[88:91], v[64:67]
    s_add_u32 s28, s38, 28672
    buffer_load_dwordx4 v[136:139], v11, s[72:75], s28 offen offset:0 sc1
    ds_read_b64_tr_b16 a[32:33], v16 offset:49152
    ds_read_b64_tr_b16 a[34:35], v16 offset:49664
    v_mfma_f32_16x16x32_bf16 v[68:71], a[36:39], v[88:91], v[68:71]
    ds_read_b64_tr_b16 a[36:37], v17 offset:49152
    ds_read_b64_tr_b16 a[38:39], v17 offset:49664
    v_mfma_f32_16x16x32_bf16 v[72:75], a[40:43], v[88:91], v[72:75]
    ds_read_b64_tr_b16 a[40:41], v18 offset:49152
    ds_read_b64_tr_b16 a[42:43], v18 offset:49664
    v_mfma_f32_16x16x32_bf16 v[76:79], a[44:47], v[88:91], v[76:79]
    ds_read_b64_tr_b16 a[44:45], v19 offset:49152
    ds_read_b64_tr_b16 a[46:47], v19 offset:49664
    s_waitcnt vmcnt(11)
    v_mfma_f32_16x16x32_bf16 v[64:67], a[48:51], v[92:95], v[64:67]
    buffer_load_dwordx4 v[140:143], v11, s[72:75], s28 offen offset:2048 sc1
    ds_read_b64_tr_b16 a[48:49], v16 offset:53248
    ds_read_b64_tr_b16 a[50:51], v16 offset:53760
    v_mfma_f32_16x16x32_bf16 v[68:71], a[52:55], v[92:95], v[68:71]
    ds_read_b64_tr_b16 a[52:53], v17 offset:53248
    ds_read_b64_tr_b16 a[54:55], v17 offset:53760
    v_mfma_f32_16x16x32_bf16 v[72:75], a[56:59], v[92:95], v[72:75]
    ds_read_b64_tr_b16 a[56:57], v18 offset:53248
    ds_read_b64_tr_b16 a[58:59], v18 offset:53760
    v_mfma_f32_16x16x32_bf16 v[76:79], a[60:63], v[92:95], v[76:79]
    ds_read_b64_tr_b16 a[60:61], v19 offset:53248
    ds_read_b64_tr_b16 a[62:63], v19 offset:53760
    s_waitcnt vmcnt(11)
    v_mfma_f32_16x16x32_bf16 v[64:67], a[64:67], v[96:99], v[64:67]
    s_add_u32 s28, s38, 32768
    buffer_load_dwordx4 v[80:83], v11, s[72:75], s28 offen offset:0 sc1
    ds_read_b64_tr_b16 a[64:65], v16 offset:57344
    ds_read_b64_tr_b16 a[66:67], v16 offset:57856
    v_mfma_f32_16x16x32_bf16 v[68:71], a[68:71], v[96:99], v[68:71]
    ds_read_b64_tr_b16 a[68:69], v17 offset:57344
    ds_read_b64_tr_b16 a[70:71], v17 offset:57856
    v_mfma_f32_16x16x32_bf16 v[72:75], a[72:75], v[96:99], v[72:75]
    ds_read_b64_tr_b16 a[72:73], v18 offset:57344
    ds_read_b64_tr_b16 a[74:75], v18 offset:57856
    v_mfma_f32_16x16x32_bf16 v[76:79], a[76:79], v[96:99], v[76:79]
    ds_read_b64_tr_b16 a[76:77], v19 offset:57344
    ds_read_b64_tr_b16 a[78:79], v19 offset:57856
    s_waitcnt vmcnt(11)
    v_mfma_f32_16x16x32_bf16 v[64:67], a[80:83], v[100:103], v[64:67]
    buffer_load_dwordx4 v[84:87], v11, s[72:75], s28 offen offset:2048 sc1
    ds_read_b64_tr_b16 a[80:81], v16 offset:61440
    ds_read_b64_tr_b16 a[82:83], v16 offset:61952
    v_mfma_f32_16x16x32_bf16 v[68:71], a[84:87], v[100:103], v[68:71]
    ds_read_b64_tr_b16 a[84:85], v17 offset:61440
    ds_read_b64_tr_b16 a[86:87], v17 offset:61952
    v_mfma_f32_16x16x32_bf16 v[72:75], a[88:91], v[100:103], v[72:75]
    ds_read_b64_tr_b16 a[88:89], v18 offset:61440
    ds_read_b64_tr_b16 a[90:91], v18 offset:61952
    v_mfma_f32_16x16x32_bf16 v[76:79], a[92:95], v[100:103], v[76:79]
    ds_read_b64_tr_b16 a[92:93], v19 offset:61440
    ds_read_b64_tr_b16 a[94:95], v19 offset:61952
    s_barrier
    s_waitcnt vmcnt(11)
    v_mfma_f32_16x16x32_bf16 v[64:67], a[96:99], v[104:107], v[64:67]
    s_add_u32 s28, s38, 36864
    buffer_load_dwordx4 v[88:91], v11, s[72:75], s28 offen offset:0 sc1
    ds_read_b64_tr_b16 a[96:97], v48 offset:61440
    ds_read_b64_tr_b16 a[98:99], v48 offset:61952
    v_mfma_f32_16x16x32_bf16 v[68:71], a[100:103], v[104:107], v[68:71]
    ds_read_b64_tr_b16 a[100:101], v49 offset:61440
    ds_read_b64_tr_b16 a[102:103], v49 offset:61952
    v_mfma_f32_16x16x32_bf16 v[72:75], a[104:107], v[104:107], v[72:75]
    ds_read_b64_tr_b16 a[104:105], v50 offset:61440
    ds_read_b64_tr_b16 a[106:107], v50 offset:61952
    v_mfma_f32_16x16x32_bf16 v[76:79], a[108:111], v[104:107], v[76:79]
    ds_read_b64_tr_b16 a[108:109], v51 offset:61440
    ds_read_b64_tr_b16 a[110:111], v51 offset:61952
    s_waitcnt vmcnt(11) lgkmcnt(15)
    v_mfma_f32_16x16x32_bf16 v[64:67], a[112:115], v[108:111], v[64:67]
    buffer_load_dwordx4 v[92:95], v11, s[72:75], s28 offen offset:2048 sc1
    ds_read_b64_tr_b16 a[112:113], v52 offset:0
    ds_read_b64_tr_b16 a[114:115], v52 offset:512
    v_mfma_f32_16x16x32_bf16 v[68:71], a[116:119], v[108:111], v[68:71]
    ds_read_b64_tr_b16 a[116:117], v53 offset:0
    ds_read_b64_tr_b16 a[118:119], v53 offset:512
    v_mfma_f32_16x16x32_bf16 v[72:75], a[120:123], v[108:111], v[72:75]
    ds_read_b64_tr_b16 a[120:121], v54 offset:0
    ds_read_b64_tr_b16 a[122:123], v54 offset:512
    v_mfma_f32_16x16x32_bf16 v[76:79], a[124:127], v[108:111], v[76:79]
    ds_read_b64_tr_b16 a[124:125], v55 offset:0
    ds_read_b64_tr_b16 a[126:127], v55 offset:512
    s_waitcnt vmcnt(11) lgkmcnt(15)
    v_mfma_f32_16x16x32_bf16 v[64:67], a[128:131], v[112:115], v[64:67]
    s_add_u32 s28, s38, 40960
    buffer_load_dwordx4 v[96:99], v11, s[72:75], s28 offen offset:0 sc1
    ds_read_b64_tr_b16 a[128:129], v52 offset:4096
    ds_read_b64_tr_b16 a[130:131], v52 offset:4608
    v_mfma_f32_16x16x32_bf16 v[68:71], a[132:135], v[112:115], v[68:71]
    ds_read_b64_tr_b16 a[132:133], v53 offset:4096
    ds_read_b64_tr_b16 a[134:135], v53 offset:4608
    v_mfma_f32_16x16x32_bf16 v[72:75], a[136:139], v[112:115], v[72:75]
    ds_read_b64_tr_b16 a[136:137], v54 offset:4096
    ds_read_b64_tr_b16 a[138:139], v54 offset:4608
    v_mfma_f32_16x16x32_bf16 v[76:79], a[140:143], v[112:115], v[76:79]
    ds_read_b64_tr_b16 a[140:141], v55 offset:4096
    ds_read_b64_tr_b16 a[142:143], v55 offset:4608
    s_waitcnt vmcnt(11) lgkmcnt(15)
    v_mfma_f32_16x16x32_bf16 v[64:67], a[144:147], v[116:119], v[64:67]
    buffer_load_dwordx4 v[100:103], v11, s[72:75], s28 offen offset:2048 sc1
    ds_read_b64_tr_b16 a[144:145], v52 offset:8192
    ds_read_b64_tr_b16 a[146:147], v52 offset:8704
    v_mfma_f32_16x16x32_bf16 v[68:71], a[148:151], v[116:119], v[68:71]
    ds_read_b64_tr_b16 a[148:149], v53 offset:8192
    ds_read_b64_tr_b16 a[150:151], v53 offset:8704
    v_mfma_f32_16x16x32_bf16 v[72:75], a[152:155], v[116:119], v[72:75]
    ds_read_b64_tr_b16 a[152:153], v54 offset:8192
    ds_read_b64_tr_b16 a[154:155], v54 offset:8704
    v_mfma_f32_16x16x32_bf16 v[76:79], a[156:159], v[116:119], v[76:79]
    ds_read_b64_tr_b16 a[156:157], v55 offset:8192
    ds_read_b64_tr_b16 a[158:159], v55 offset:8704
    s_waitcnt vmcnt(11) lgkmcnt(15)
    v_mfma_f32_16x16x32_bf16 v[64:67], a[160:163], v[120:123], v[64:67]
    s_add_u32 s28, s38, 45056
    buffer_load_dwordx4 v[104:107], v11, s[72:75], s28 offen offset:0 sc1
    ds_read_b64_tr_b16 a[160:161], v52 offset:12288
    ds_read_b64_tr_b16 a[162:163], v52 offset:12800
    v_mfma_f32_16x16x32_bf16 v[68:71], a[164:167], v[120:123], v[68:71]
    ds_read_b64_tr_b16 a[164:165], v53 offset:12288
    ds_read_b64_tr_b16 a[166:167], v53 offset:12800
    v_mfma_f32_16x16x32_bf16 v[72:75], a[168:171], v[120:123], v[72:75]
    ds_read_b64_tr_b16 a[168:169], v54 offset:12288
    ds_read_b64_tr_b16 a[170:171], v54 offset:12800
    v_mfma_f32_16x16x32_bf16 v[76:79], a[172:175], v[120:123], v[76:79]
    ds_read_b64_tr_b16 a[172:173], v55 offset:12288
    ds_read_b64_tr_b16 a[174:175], v55 offset:12800
    s_waitcnt vmcnt(11) lgkmcnt(15)
    v_mfma_f32_16x16x32_bf16 v[64:67], a[176:179], v[124:127], v[64:67]
    buffer_load_dwordx4 v[108:111], v11, s[72:75], s28 offen offset:2048 sc1
    ds_read_b64_tr_b16 a[176:177], v52 offset:16384
    ds_read_b64_tr_b16 a[178:179], v52 offset:16896
    v_mfma_f32_16x16x32_bf16 v[68:71], a[180:183], v[124:127], v[68:71]
    ds_read_b64_tr_b16 a[180:181], v53 offset:16384
    ds_read_b64_tr_b16 a[182:183], v53 offset:16896
    v_mfma_f32_16x16x32_bf16 v[72:75], a[184:187], v[124:127], v[72:75]
    ds_read_b64_tr_b16 a[184:185], v54 offset:16384
    ds_read_b64_tr_b16 a[186:187], v54 offset:16896
    v_mfma_f32_16x16x32_bf16 v[76:79], a[188:191], v[124:127], v[76:79]
    ds_read_b64_tr_b16 a[188:189], v55 offset:16384
    ds_read_b64_tr_b16 a[190:191], v55 offset:16896
    s_waitcnt vmcnt(11) lgkmcnt(15)
    v_mfma_f32_16x16x32_bf16 v[64:67], a[192:195], v[128:131], v[64:67]
    s_add_u32 s28, s38, 49152
    buffer_load_dwordx4 v[112:115], v11, s[72:75], s28 offen offset:0 sc1
    ds_read_b64_tr_b16 a[192:193], v52 offset:20480
    ds_read_b64_tr_b16 a[194:195], v52 offset:20992
    v_mfma_f32_16x16x32_bf16 v[68:71], a[196:199], v[128:131], v[68:71]
    ds_read_b64_tr_b16 a[196:197], v53 offset:20480
    ds_read_b64_tr_b16 a[198:199], v53 offset:20992
    v_mfma_f32_16x16x32_bf16 v[72:75], a[200:203], v[128:131], v[72:75]
    ds_read_b64_tr_b16 a[200:201], v54 offset:20480
    ds_read_b64_tr_b16 a[202:203], v54 offset:20992
    v_mfma_f32_16x16x32_bf16 v[76:79], a[204:207], v[128:131], v[76:79]
    ds_read_b64_tr_b16 a[204:205], v55 offset:20480
    ds_read_b64_tr_b16 a[206:207], v55 offset:20992
    s_waitcnt vmcnt(11) lgkmcnt(15)
    v_mfma_f32_16x16x32_bf16 v[64:67], a[208:211], v[132:135], v[64:67]
    buffer_load_dwordx4 v[116:119], v11, s[72:75], s28 offen offset:2048 sc1
    ds_read_b64_tr_b16 a[208:209], v52 offset:24576
    ds_read_b64_tr_b16 a[210:211], v52 offset:25088
    v_mfma_f32_16x16x32_bf16 v[68:71], a[212:215], v[132:135], v[68:71]
    ds_read_b64_tr_b16 a[212:213], v53 offset:24576
    ds_read_b64_tr_b16 a[214:215], v53 offset:25088
    v_mfma_f32_16x16x32_bf16 v[72:75], a[216:219], v[132:135], v[72:75]
    ds_read_b64_tr_b16 a[216:217], v54 offset:24576
    ds_read_b64_tr_b16 a[218:219], v54 offset:25088
    v_mfma_f32_16x16x32_bf16 v[76:79], a[220:223], v[132:135], v[76:79]
    ds_read_b64_tr_b16 a[220:221], v55 offset:24576
    ds_read_b64_tr_b16 a[222:223], v55 offset:25088
    s_waitcnt vmcnt(11) lgkmcnt(15)
    v_mfma_f32_16x16x32_bf16 v[64:67], a[224:227], v[136:139], v[64:67]
    s_add_u32 s28, s38, 53248
    buffer_load_dwordx4 v[120:123], v11, s[72:75], s28 offen offset:0 sc1
    ds_read_b64_tr_b16 a[224:225], v48 offset:0
    ds_read_b64_tr_b16 a[226:227], v48 offset:512
    v_mfma_f32_16x16x32_bf16 v[68:71], a[228:231], v[136:139], v[68:71]
    ds_read_b64_tr_b16 a[228:229], v49 offset:0
    ds_read_b64_tr_b16 a[230:231], v49 offset:512
    v_mfma_f32_16x16x32_bf16 v[72:75], a[232:235], v[136:139], v[72:75]
    ds_read_b64_tr_b16 a[232:233], v50 offset:0
    ds_read_b64_tr_b16 a[234:235], v50 offset:512
    v_mfma_f32_16x16x32_bf16 v[76:79], a[236:239], v[136:139], v[76:79]
    ds_read_b64_tr_b16 a[236:237], v51 offset:0
    ds_read_b64_tr_b16 a[238:239], v51 offset:512
    s_waitcnt vmcnt(11) lgkmcnt(15)
    v_mfma_f32_16x16x32_bf16 v[64:67], a[240:243], v[140:143], v[64:67]
    buffer_load_dwordx4 v[124:127], v11, s[72:75], s28 offen offset:2048 sc1
    ds_read_b64_tr_b16 a[240:241], v48 offset:4096
    ds_read_b64_tr_b16 a[242:243], v48 offset:4608
    v_mfma_f32_16x16x32_bf16 v[68:71], a[244:247], v[140:143], v[68:71]
    ds_read_b64_tr_b16 a[244:245], v49 offset:4096
    ds_read_b64_tr_b16 a[246:247], v49 offset:4608
    v_mfma_f32_16x16x32_bf16 v[72:75], a[248:251], v[140:143], v[72:75]
    ds_read_b64_tr_b16 a[248:249], v50 offset:4096
    ds_read_b64_tr_b16 a[250:251], v50 offset:4608
    v_mfma_f32_16x16x32_bf16 v[76:79], a[252:255], v[140:143], v[76:79]
    ds_read_b64_tr_b16 a[252:253], v51 offset:4096
    ds_read_b64_tr_b16 a[254:255], v51 offset:4608
    s_waitcnt vmcnt(11) lgkmcnt(15)
    v_mfma_f32_16x16x32_bf16 v[64:67], v[144:147], v[80:83], v[64:67]
    s_add_u32 s28, s38, 57344
    buffer_load_dwordx4 v[128:131], v11, s[72:75], s28 offen offset:0 sc1
    ds_read_b64_tr_b16 v[144:145], v48 offset:8192
    ds_read_b64_tr_b16 v[146:147], v48 offset:8704
    v_mfma_f32_16x16x32_bf16 v[68:71], v[148:151], v[80:83], v[68:71]
    ds_read_b64_tr_b16 v[148:149], v49 offset:8192
    ds_read_b64_tr_b16 v[150:151], v49 offset:8704
    v_mfma_f32_16x16x32_bf16 v[72:75], v[152:155], v[80:83], v[72:75]
    ds_read_b64_tr_b16 v[152:153], v50 offset:8192
    ds_read_b64_tr_b16 v[154:155], v50 offset:8704
    v_mfma_f32_16x16x32_bf16 v[76:79], v[156:159], v[80:83], v[76:79]
    ds_read_b64_tr_b16 v[156:157], v51 offset:8192
    ds_read_b64_tr_b16 v[158:159], v51 offset:8704
    s_waitcnt vmcnt(11) lgkmcnt(15)
    v_mfma_f32_16x16x32_bf16 v[64:67], v[160:163], v[84:87], v[64:67]
    buffer_load_dwordx4 v[132:135], v11, s[72:75], s28 offen offset:2048 sc1
    ds_read_b64_tr_b16 v[160:161], v48 offset:12288
    ds_read_b64_tr_b16 v[162:163], v48 offset:12800
    v_mfma_f32_16x16x32_bf16 v[68:71], v[164:167], v[84:87], v[68:71]
    ds_read_b64_tr_b16 v[164:165], v49 offset:12288
    ds_read_b64_tr_b16 v[166:167], v49 offset:12800
    v_mfma_f32_16x16x32_bf16 v[72:75], v[168:171], v[84:87], v[72:75]
    ds_read_b64_tr_b16 v[168:169], v50 offset:12288
    ds_read_b64_tr_b16 v[170:171], v50 offset:12800
    v_mfma_f32_16x16x32_bf16 v[76:79], v[172:175], v[84:87], v[76:79]
    ds_read_b64_tr_b16 v[172:173], v51 offset:12288
    ds_read_b64_tr_b16 v[174:175], v51 offset:12800
    s_waitcnt vmcnt(11) lgkmcnt(15)
    v_mfma_f32_16x16x32_bf16 v[64:67], v[176:179], v[88:91], v[64:67]
    s_add_u32 s28, s38, 61440
    buffer_load_dwordx4 v[136:139], v11, s[72:75], s28 offen offset:0 sc1
    ds_read_b64_tr_b16 v[176:177], v48 offset:16384
    ds_read_b64_tr_b16 v[178:179], v48 offset:16896
    v_mfma_f32_16x16x32_bf16 v[68:71], v[180:183], v[88:91], v[68:71]
    ds_read_b64_tr_b16 v[180:181], v49 offset:16384
    ds_read_b64_tr_b16 v[182:183], v49 offset:16896
    v_mfma_f32_16x16x32_bf16 v[72:75], v[184:187], v[88:91], v[72:75]
    ds_read_b64_tr_b16 v[184:185], v50 offset:16384
    ds_read_b64_tr_b16 v[186:187], v50 offset:16896
    v_mfma_f32_16x16x32_bf16 v[76:79], v[188:191], v[88:91], v[76:79]
    ds_read_b64_tr_b16 v[188:189], v51 offset:16384
    ds_read_b64_tr_b16 v[190:191], v51 offset:16896
    s_waitcnt vmcnt(11) lgkmcnt(15)
    v_mfma_f32_16x16x32_bf16 v[64:67], v[192:195], v[92:95], v[64:67]
    buffer_load_dwordx4 v[140:143], v11, s[72:75], s28 offen offset:2048 sc1
    v_mfma_f32_16x16x32_bf16 v[68:71], v[196:199], v[92:95], v[68:71]
    v_mfma_f32_16x16x32_bf16 v[72:75], v[200:203], v[92:95], v[72:75]
    v_mfma_f32_16x16x32_bf16 v[76:79], v[204:207], v[92:95], v[76:79]
    s_waitcnt vmcnt(11) lgkmcnt(15)
    v_mfma_f32_16x16x32_bf16 v[64:67], v[208:211], v[96:99], v[64:67]
    s_add_u32 s28, s38, 65536
    buffer_load_dwordx4 v[80:83], v11, s[72:75], s28 offen offset:0 sc1
    v_mfma_f32_16x16x32_bf16 v[68:71], v[212:215], v[96:99], v[68:71]
    v_mfma_f32_16x16x32_bf16 v[72:75], v[216:219], v[96:99], v[72:75]
    v_mfma_f32_16x16x32_bf16 v[76:79], v[220:223], v[96:99], v[76:79]
    s_waitcnt vmcnt(11) lgkmcnt(15)
    v_mfma_f32_16x16x32_bf16 v[64:67], v[224:227], v[100:103], v[64:67]
    buffer_load_dwordx4 v[84:87], v11, s[72:75], s28 offen offset:2048 sc1
    v_mfma_f32_16x16x32_bf16 v[68:71], v[228:231], v[100:103], v[68:71]
    v_mfma_f32_16x16x32_bf16 v[72:75], v[232:235], v[100:103], v[72:75]
    v_mfma_f32_16x16x32_bf16 v[76:79], v[236:239], v[100:103], v[76:79]
    s_waitcnt vmcnt(11) lgkmcnt(15)
    v_mfma_f32_16x16x32_bf16 v[64:67], v[240:243], v[104:107], v[64:67]
    s_add_u32 s28, s38, 69632
    buffer_load_dwordx4 v[88:91], v11, s[72:75], s28 offen offset:0 sc1
    v_mfma_f32_16x16x32_bf16 v[68:71], v[244:247], v[104:107], v[68:71]
    v_mfma_f32_16x16x32_bf16 v[72:75], v[248:251], v[104:107], v[72:75]
    v_mfma_f32_16x16x32_bf16 v[76:79], v[252:255], v[104:107], v[76:79]
    s_waitcnt vmcnt(11) lgkmcnt(15)
    v_mfma_f32_16x16x32_bf16 v[64:67], a[0:3], v[108:111], v[64:67]
    buffer_load_dwordx4 v[92:95], v11, s[72:75], s28 offen offset:2048 sc1
    v_mfma_f32_16x16x32_bf16 v[68:71], a[4:7], v[108:111], v[68:71]
    v_mfma_f32_16x16x32_bf16 v[72:75], a[8:11], v[108:111], v[72:75]
    v_mfma_f32_16x16x32_bf16 v[76:79], a[12:15], v[108:111], v[76:79]
    s_waitcnt vmcnt(11) lgkmcnt(15)
    v_mfma_f32_16x16x32_bf16 v[64:67], a[16:19], v[112:115], v[64:67]
    s_add_u32 s28, s38, 73728
    buffer_load_dwordx4 v[96:99], v11, s[72:75], s28 offen offset:0 sc1
    v_mfma_f32_16x16x32_bf16 v[68:71], a[20:23], v[112:115], v[68:71]
    v_mfma_f32_16x16x32_bf16 v[72:75], a[24:27], v[112:115], v[72:75]
    v_mfma_f32_16x16x32_bf16 v[76:79], a[28:31], v[112:115], v[76:79]
    s_waitcnt vmcnt(11) lgkmcnt(15)
    v_mfma_f32_16x16x32_bf16 v[64:67], a[32:35], v[116:119], v[64:67]
    buffer_load_dwordx4 v[100:103], v11, s[72:75], s28 offen offset:2048 sc1
    v_mfma_f32_16x16x32_bf16 v[68:71], a[36:39], v[116:119], v[68:71]
    v_mfma_f32_16x16x32_bf16 v[72:75], a[40:43], v[116:119], v[72:75]
    v_mfma_f32_16x16x32_bf16 v[76:79], a[44:47], v[116:119], v[76:79]
    s_waitcnt vmcnt(11) lgkmcnt(15)
    v_mfma_f32_16x16x32_bf16 v[64:67], a[48:51], v[120:123], v[64:67]
    s_add_u32 s28, s38, 77824
    buffer_load_dwordx4 v[104:107], v11, s[72:75], s28 offen offset:0 sc1
    v_mfma_f32_16x16x32_bf16 v[68:71], a[52:55], v[120:123], v[68:71]
    v_mfma_f32_16x16x32_bf16 v[72:75], a[56:59], v[120:123], v[72:75]
    v_mfma_f32_16x16x32_bf16 v[76:79], a[60:63], v[120:123], v[76:79]
    s_waitcnt vmcnt(11) lgkmcnt(15)
    v_mfma_f32_16x16x32_bf16 v[64:67], a[64:67], v[124:127], v[64:67]
    buffer_load_dwordx4 v[108:111], v11, s[72:75], s28 offen offset:2048 sc1
    v_mfma_f32_16x16x32_bf16 v[68:71], a[68:71], v[124:127], v[68:71]
    v_mfma_f32_16x16x32_bf16 v[72:75], a[72:75], v[124:127], v[72:75]
    v_mfma_f32_16x16x32_bf16 v[76:79], a[76:79], v[124:127], v[76:79]
    s_waitcnt vmcnt(11) lgkmcnt(15)
    v_mfma_f32_16x16x32_bf16 v[64:67], a[80:83], v[128:131], v[64:67]
    s_add_u32 s28, s38, 81920
    buffer_load_dwordx4 v[112:115], v11, s[72:75], s28 offen offset:0 sc1
    ds_read_b64_tr_b16 v[192:193], v48 offset:20480
    ds_read_b64_tr_b16 v[194:195], v48 offset:20992
    v_mfma_f32_16x16x32_bf16 v[68:71], a[84:87], v[128:131], v[68:71]
    ds_read_b64_tr_b16 v[196:197], v49 offset:20480
    ds_read_b64_tr_b16 v[198:199], v49 offset:20992
    v_mfma_f32_16x16x32_bf16 v[72:75], a[88:91], v[128:131], v[72:75]
    ds_read_b64_tr_b16 v[200:201], v50 offset:20480
    ds_read_b64_tr_b16 v[202:203], v50 offset:20992
    v_mfma_f32_16x16x32_bf16 v[76:79], a[92:95], v[128:131], v[76:79]
    ds_read_b64_tr_b16 v[204:205], v51 offset:20480
    ds_read_b64_tr_b16 v[206:207], v51 offset:20992
    s_waitcnt vmcnt(11) lgkmcnt(15)
    v_mfma_f32_16x16x32_bf16 v[64:67], a[96:99], v[132:135], v[64:67]
    buffer_load_dwordx4 v[116:119], v11, s[72:75], s28 offen offset:2048 sc1
    v_mfma_f32_16x16x32_bf16 v[68:71], a[100:103], v[132:135], v[68:71]
    v_mfma_f32_16x16x32_bf16 v[72:75], a[104:107], v[132:135], v[72:75]
    v_mfma_f32_16x16x32_bf16 v[76:79], a[108:111], v[132:135], v[76:79]
    s_waitcnt vmcnt(11) lgkmcnt(15)
    v_mfma_f32_16x16x32_bf16 v[64:67], a[112:115], v[136:139], v[64:67]
    s_add_u32 s28, s38, 86016
    buffer_load_dwordx4 v[120:123], v11, s[72:75], s28 offen offset:0 sc1
    v_mfma_f32_16x16x32_bf16 v[68:71], a[116:119], v[136:139], v[68:71]
    v_mfma_f32_16x16x32_bf16 v[72:75], a[120:123], v[136:139], v[72:75]
    v_mfma_f32_16x16x32_bf16 v[76:79], a[124:127], v[136:139], v[76:79]
    s_waitcnt vmcnt(11) lgkmcnt(15)
    v_mfma_f32_16x16x32_bf16 v[64:67], a[128:131], v[140:143], v[64:67]
    v_mfma_f32_16x16x32_bf16 v[68:71], a[132:135], v[140:143], v[68:71]
    v_mfma_f32_16x16x32_bf16 v[72:75], a[136:139], v[140:143], v[72:75]
    v_mfma_f32_16x16x32_bf16 v[76:79], a[140:143], v[140:143], v[76:79]
    s_waitcnt vmcnt(10) lgkmcnt(15)
    v_mfma_f32_16x16x32_bf16 v[64:67], a[144:147], v[80:83], v[64:67]
    v_mfma_f32_16x16x32_bf16 v[68:71], a[148:151], v[80:83], v[68:71]
    v_mfma_f32_16x16x32_bf16 v[72:75], a[152:155], v[80:83], v[72:75]
    v_mfma_f32_16x16x32_bf16 v[76:79], a[156:159], v[80:83], v[76:79]
    s_waitcnt vmcnt(9) lgkmcnt(15)
    v_mfma_f32_16x16x32_bf16 v[64:67], a[160:163], v[84:87], v[64:67]
    v_mfma_f32_16x16x32_bf16 v[68:71], a[164:167], v[84:87], v[68:71]
    v_mfma_f32_16x16x32_bf16 v[72:75], a[168:171], v[84:87], v[72:75]
    v_mfma_f32_16x16x32_bf16 v[76:79], a[172:175], v[84:87], v[76:79]
    s_waitcnt vmcnt(8) lgkmcnt(15)
    v_mfma_f32_16x16x32_bf16 v[64:67], a[176:179], v[88:91], v[64:67]
    v_mfma_f32_16x16x32_bf16 v[68:71], a[180:183], v[88:91], v[68:71]
    v_mfma_f32_16x16x32_bf16 v[72:75], a[184:187], v[88:91], v[72:75]
    v_mfma_f32_16x16x32_bf16 v[76:79], a[188:191], v[88:91], v[76:79]
    s_waitcnt vmcnt(7) lgkmcnt(15)
    v_mfma_f32_16x16x32_bf16 v[64:67], a[192:195], v[92:95], v[64:67]
    v_mfma_f32_16x16x32_bf16 v[68:71], a[196:199], v[92:95], v[68:71]
    v_mfma_f32_16x16x32_bf16 v[72:75], a[200:203], v[92:95], v[72:75]
    v_mfma_f32_16x16x32_bf16 v[76:79], a[204:207], v[92:95], v[76:79]
    s_waitcnt vmcnt(6) lgkmcnt(15)
    v_mfma_f32_16x16x32_bf16 v[64:67], a[208:211], v[96:99], v[64:67]
    v_mfma_f32_16x16x32_bf16 v[68:71], a[212:215], v[96:99], v[68:71]
    v_mfma_f32_16x16x32_bf16 v[72:75], a[216:219], v[96:99], v[72:75]
    v_mfma_f32_16x16x32_bf16 v[76:79], a[220:223], v[96:99], v[76:79]
    s_waitcnt vmcnt(5) lgkmcnt(15)
    v_mfma_f32_16x16x32_bf16 v[64:67], a[224:227], v[100:103], v[64:67]
    v_mfma_f32_16x16x32_bf16 v[68:71], a[228:231], v[100:103], v[68:71]
    v_mfma_f32_16x16x32_bf16 v[72:75], a[232:235], v[100:103], v[72:75]
    v_mfma_f32_16x16x32_bf16 v[76:79], a[236:239], v[100:103], v[76:79]
    s_waitcnt vmcnt(4) lgkmcnt(15)
    v_mfma_f32_16x16x32_bf16 v[64:67], a[240:243], v[104:107], v[64:67]
    v_mfma_f32_16x16x32_bf16 v[68:71], a[244:247], v[104:107], v[68:71]
    v_mfma_f32_16x16x32_bf16 v[72:75], a[248:251], v[104:107], v[72:75]
    v_mfma_f32_16x16x32_bf16 v[76:79], a[252:255], v[104:107], v[76:79]
    s_waitcnt vmcnt(3) lgkmcnt(15)
    v_mfma_f32_16x16x32_bf16 v[64:67], v[144:147], v[108:111], v[64:67]
    v_mfma_f32_16x16x32_bf16 v[68:71], v[148:151], v[108:111], v[68:71]
    v_mfma_f32_16x16x32_bf16 v[72:75], v[152:155], v[108:111], v[72:75]
    v_mfma_f32_16x16x32_bf16 v[76:79], v[156:159], v[108:111], v[76:79]
    s_waitcnt vmcnt(2) lgkmcnt(15)
    v_mfma_f32_16x16x32_bf16 v[64:67], v[160:163], v[112:115], v[64:67]
    v_mfma_f32_16x16x32_bf16 v[68:71], v[164:167], v[112:115], v[68:71]
    v_mfma_f32_16x16x32_bf16 v[72:75], v[168:171], v[112:115], v[72:75]
    v_mfma_f32_16x16x32_bf16 v[76:79], v[172:175], v[112:115], v[76:79]
    v_lshlrev_b32 v80, 16, v24
    v_and_b32 v81, s86, v24
    v_lshlrev_b32 v82, 16, v25
    v_and_b32 v83, s86, v25
    v_lshlrev_b32 v84, 16, v26
    v_and_b32 v85, s86, v26
    v_lshlrev_b32 v86, 16, v27
    v_and_b32 v87, s86, v27
    v_lshlrev_b32 v88, 16, v28
    v_and_b32 v89, s86, v28
    v_lshlrev_b32 v90, 16, v29
    v_and_b32 v91, s86, v29
    v_lshlrev_b32 v92, 16, v30
    v_and_b32 v93, s86, v30
    v_lshlrev_b32 v94, 16, v31
    v_and_b32 v95, s86, v31
    s_waitcnt vmcnt(1) lgkmcnt(8)
    v_mfma_f32_16x16x32_bf16 v[64:67], v[176:179], v[116:119], v[64:67]
    v_mfma_f32_16x16x32_bf16 v[68:71], v[180:183], v[116:119], v[68:71]
    v_mfma_f32_16x16x32_bf16 v[72:75], v[184:187], v[116:119], v[72:75]
    v_mfma_f32_16x16x32_bf16 v[76:79], v[188:191], v[116:119], v[76:79]
    s_waitcnt vmcnt(0) lgkmcnt(0)
    v_mfma_f32_16x16x32_bf16 v[64:67], v[192:195], v[120:123], v[64:67]
    v_mfma_f32_16x16x32_bf16 v[68:71], v[196:199], v[120:123], v[68:71]
    v_mfma_f32_16x16x32_bf16 v[72:75], v[200:203], v[120:123], v[72:75]
    v_mfma_f32_16x16x32_bf16 v[76:79], v[204:207], v[120:123], v[76:79]
    s_nop 4
    v_pk_fma_f32 v[64:65], v[64:65], v[32:33], v[80:81]
    v_pk_fma_f32 v[66:67], v[66:67], v[34:35], v[82:83]
    v_pk_fma_f32 v[68:69], v[68:69], v[36:37], v[84:85]
    v_pk_fma_f32 v[70:71], v[70:71], v[38:39], v[86:87]
    v_pk_fma_f32 v[72:73], v[72:73], v[40:41], v[88:89]
    v_pk_fma_f32 v[74:75], v[74:75], v[42:43], v[90:91]
    v_pk_fma_f32 v[76:77], v[76:77], v[44:45], v[92:93]
    v_pk_fma_f32 v[78:79], v[78:79], v[46:47], v[94:95]
    v_cvt_pk_bf16_f32 v24, v64, v65
    v_cvt_pk_bf16_f32 v25, v66, v67
    v_cvt_pk_bf16_f32 v26, v68, v69
    v_cvt_pk_bf16_f32 v27, v70, v71
    v_cvt_pk_bf16_f32 v28, v72, v73
    v_cvt_pk_bf16_f32 v29, v74, v75
    v_cvt_pk_bf16_f32 v30, v76, v77
    v_cvt_pk_bf16_f32 v31, v78, v79
    v_permlane16_swap_b32 v24, v26
    v_permlane16_swap_b32 v25, v27
    v_permlane16_swap_b32 v28, v30
    v_permlane16_swap_b32 v29, v31
    buffer_store_dwordx4 v[24:27], v61, s[68:71], s88 offen offset:0 nt
    buffer_store_dwordx4 v[28:31], v61, s[68:71], s88 offen offset:64 nt
L_giveup:
    s_endpgm
.rept 256
    s_endpgm
.endr
L_codeend:
.section .rodata,"a"
.p2align 6
.amdhsa_kernel adaLN_cond__sliding_local_dilated__glu_gated_glu__prompt_kernel
  .amdhsa_next_free_vgpr 512
  .amdhsa_next_free_sgpr 102
  .amdhsa_accum_offset 256
  .amdhsa_group_segment_fixed_size 0
  .amdhsa_kernarg_size 96
  .amdhsa_user_sgpr_count 2
  .amdhsa_user_sgpr_kernarg_segment_ptr 1
  .amdhsa_system_sgpr_workgroup_id_x 1
.end_amdhsa_kernel
```
